```python
import torch

def _softmax(x, axis=-1):
    return torch.softmax(x, dim=axis)
def _gelu(x):
    return torch.nn.functional.gelu(x, approximate="tanh")
def _silu(x):
    return torch.nn.functional.silu(x)
def _sigmoid(x):
    return torch.sigmoid(x)
def _layernorm(x, axis=-1, eps=1e-5):
    m = x.mean(dim=axis, keepdim=True)
    v = x.var(dim=axis, keepdim=True, unbiased=False)
    return (x - m) / torch.sqrt(v + eps)
def _scatter_add(tgt, idx, src, axis=0):
    return tgt.clone().index_add_(axis, idx, src)
def _segment_sum(src, seg, n):
    out = torch.zeros((n,) + src.shape[1:], dtype=src.dtype)
    return out.index_add_(0, seg, src)
def _pad(x, pw):
    flat = tuple(v for pair in reversed(pw) for v in pair)
    return torch.nn.functional.pad(x, flat)

kernel_name = 'standalone__softmax_full_mha__prompt'

def setup_inputs():

    _w = (lambda a: (lambda t: t.to(torch.bfloat16) if t.is_floating_point() else t)(torch.as_tensor(a)))
    B, S, D = 1, 2048, 448
    return {
        "x": _w((lambda *s: torch.randn(*s, dtype=torch.bfloat16) * 0.2)(B, S, D)),
        "wqkv": _w((lambda *s: torch.randn(*s, dtype=torch.bfloat16) * 0.2)(D, 3 * D)),
        "wo": _w((lambda *s: torch.randn(*s, dtype=torch.bfloat16) * 0.05)(D, D)),
    }

def reference(x, wqkv, wo):
    B, S, D = x.shape
    H = 16; Dh = D // H
    qkv = (lambda x, *d: x.permute(*d))((x @ wqkv).reshape(B, S, 3, H, Dh), 2, 0, 3, 1, 4)
    q, k, v = qkv[0], qkv[1], qkv[2]
    scale = Dh ** -0.5
    scores = torch.einsum("bhqd,bhkd->bhqk", q, k) * scale
    p = _softmax(scores, axis=-1)
    o = torch.einsum("bhqk,bhkd->bhqd", p, v)
    return (lambda x, *d: x.permute(*d))(o, 0, 2, 1, 3).reshape(B, S, D) @ wo
```

```asm
; @launch grid=(256,1,1) block=(512,1,1) lds=163840
.amdgcn_target "amdgcn-amd-amdhsa--gfx950"
.text
.globl standalone__softmax_full_mha__prompt_kernel
.p2align 8
.type standalone__softmax_full_mha__prompt_kernel,@function
standalone__softmax_full_mha__prompt_kernel:
    s_cmp_ge_u32 s2, 256
    s_cbranch_scc1 L_done
    s_load_dwordx4 s[36:39], s[0:1], 0
    s_load_dwordx4 s[40:43], s[0:1], 16
    s_load_dwordx4 s[4:7], s[0:1], 32
    s_memrealtime s[62:63]
    v_lshrrev_b32 v16, 6, v0
    v_and_b32 v1, 63, v0
    s_and_b32 s34, s2, 3
    s_bfe_u32 s35, s2, 0x30003
    v_readfirstlane_b32 s31, v16
    s_lshl_b32 s52, s34, 3
    s_add_u32 s52, s52, s35
    s_lshr_b32 s55, s2, 6
    s_lshl_b32 s46, s55, 1
    s_add_u32 s46, s46, s35
    s_cmp_ge_u32 s46, 7
    s_cselect_b32 s35, 7, 0
    s_sub_u32 s46, s46, s35
    s_and_b32 s35, s2, 4
    s_lshr_b32 s34, s2, 3
    s_xor_b32 s34, s34, s2
    s_and_b32 s34, s34, 4
    s_cmp_eq_u32 s55, 3
    s_cselect_b32 s35, s34, s35
    s_add_u32 s55, s55, s35
    s_mov_b32 s10, 1835008
    s_mov_b32 s11, 0x00020000
    s_mov_b32 s14, 1204224
    s_mov_b32 s15, 0x00020000
    s_cmp_lg_u32 s55, 7
    s_cbranch_scc1 L_work
    s_getpc_b64 s[44:45]
L_pc:
    s_sub_u32 s44, s44, L_pc-standalone__softmax_full_mha__prompt_kernel
    s_subb_u32 s45, s45, 0
    s_mov_b32 s46, L_end-standalone__softmax_full_mha__prompt_kernel
    s_mov_b32 s47, 0x00020000
    v_lshlrev_b32 v26, 7, v0
    buffer_load_dword v27, v26, s[44:47], 0 offen
    s_and_b32 s34, s52, 3
    s_and_b32 s35, s2, 4
    s_cmp_eq_u32 s34, 3
    s_cselect_b32 s35, 0, s35
    s_add_u32 s34, s34, s35
    s_lshl_b32 s34, s34, 7
    v_mul_u32_u24 v26, 2688, v0
    s_waitcnt lgkmcnt(0)
    s_mov_b32 s12, s38
    s_mov_b32 s13, s39

    buffer_load_dword v27, v26, s[12:15], s34 offen
    s_branch L_sp1
L_work:
    v_lshrrev_b32 v18, 3, v0
    v_and_b32 v17, 7, v1
    v_bfe_u32 v19, v0, 4, 3
    v_xor_b32 v19, v19, v17
    v_mul_u32_u24 v2, 896, v18
    v_lshl_add_u32 v2, v19, 4, v2
    v_lshrrev_b32 v19, 2, v1
    v_and_b32 v19, 4, v19
    v_xor_b32 v19, v19, v17
    v_mul_u32_u24 v3, 2688, v18
    v_lshl_add_u32 v3, v19, 4, v3
    s_mul_i32 s51, s52, 57344
    s_lshl_b32 s49, s55, 7
    s_lshl_b32 s50, s31, 10
    s_waitcnt lgkmcnt(0)
    s_mov_b32 s8, s36
    s_mov_b32 s9, s37
    s_mov_b32 s12, s38
    s_mov_b32 s13, s39

    s_lshl_b32 s47, s46, 7
    s_add_u32 s47, s47, s51
    s_add_u32 m0, s50, 0
    s_mul_i32 s48, s46, 172032
    buffer_load_dwordx4 v2, s[8:11], s47 offen lds
    s_add_u32 m0, s50, 7296
    s_add_u32 s48, s48, s49
    buffer_load_dwordx4 v3, s[12:15], s48 offen offset:896 lds
    s_add_u32 m0, s50, 14592
    s_add_u32 s46, s46, 1
    buffer_load_dwordx4 v3, s[12:15], s48 offen offset:1792 lds
    s_cmp_eq_u32 s46, 7
    s_cselect_b32 s46, 0, s46

    s_lshl_b32 s47, s46, 7
    s_add_u32 s47, s47, s51
    s_add_u32 m0, s50, 24576
    s_mul_i32 s48, s46, 172032
    buffer_load_dwordx4 v2, s[8:11], s47 offen lds
    s_add_u32 m0, s50, 31872
    s_add_u32 s48, s48, s49
    buffer_load_dwordx4 v3, s[12:15], s48 offen offset:896 lds
    s_add_u32 m0, s50, 39168
    s_add_u32 s46, s46, 1
    buffer_load_dwordx4 v3, s[12:15], s48 offen offset:1792 lds
    s_cmp_eq_u32 s46, 7
    s_cselect_b32 s46, 0, s46

L_sp1:
    s_mov_b32 s16, s6
    s_mov_b32 s17, s7
    s_mov_b32 s6, 256
    s_mov_b32 s7, 0x00020000
    s_mov_b32 s18, 13631488
    s_mov_b32 s19, 0x00020000
    s_mov_b32 s20, s40
    s_mov_b32 s21, s41
    s_mov_b32 s24, s42
    s_mov_b32 s25, s43
    s_mov_b32 s22, 401408
    s_mov_b32 s23, 0x00020000
    s_mov_b32 s26, 1835008
    s_mov_b32 s27, 0x00020000
    v_mov_b32 v7, 0
    s_bfe_u32 s28, s2, 0x40003
    s_and_b32 s34, s2, 7
    s_lshl_b32 s34, s34, 1
    s_lshr_b32 s35, s2, 7
    s_add_u32 s32, s34, s35
    s_and_b32 s61, s31, 3
    s_lshr_b32 s60, s31, 2
    s_lshl_b32 s34, s28, 2
    s_add_u32 s53, s34, s61
    s_lshl_b32 s34, s53, 15
    s_lshl_b32 s35, s32, 11
    s_add_u32 s40, s34, s35
    s_lshl_b32 s34, s60, 10
    s_add_u32 s40, s40, s34
    s_add_u32 s40, s40, 8388608
    s_mov_b32 s41, 10485760
    s_lshl_b32 s57, s2, 7
    s_add_u32 s57, s57, 10485760
    v_lshlrev_b32 v123, 4, v1
    v_mov_b32 v16, 1073741824
    v_lshrrev_b32 v17, 5, v0
    v_and_b32 v18, 15, v1
    v_lshlrev_b32 v18, 3, v18
    v_and_b32 v19, 16, v1
    v_lshl_add_u32 v18, v19, 11, v18
    v_cmp_eq_u32 vcc, 14, v17
    v_mov_b32 v124, -1
    v_mov_b32 v125, -1
    v_mov_b32 v126, -1
    v_mov_b32 v127, -1
    v_cndmask_b32 v6, v16, v18, vcc
    s_cmp_eq_u32 s55, 7
    s_cbranch_scc1 L_spare_1
    v_and_b32 v16, 31, v1
    v_lshrrev_b32 v17, 5, v1
    s_bfe_u32 s56, s31, 0x10001
    s_lshl_b32 s34, s55, 1
    s_add_u32 s58, s56, s34
    s_and_b32 s34, s31, 1
    s_lshl_b32 s34, s34, 12
    s_lshl_b32 s54, s52, 13
    s_add_u32 s54, s54, s34
    v_bfe_u32 v18, v1, 1, 3
    v_xor_b32 v18, v18, v17
    v_lshlrev_b32 v19, 7, v16
    v_lshl_add_u32 v18, v18, 4, v19
    v_add_u32 v8, s34, v18
    v_xor_b32 v9, 32, v8
    v_xor_b32 v10, 64, v8
    v_xor_b32 v11, 0x60, v8
    v_add_u32 v12, 49152, v8
    v_add_u32 v13, 49152, v9
    v_add_u32 v14, 49152, v10
    v_add_u32 v15, 49152, v11
    v_and_b32 v18, 3, v1
    v_lshrrev_b32 v19, 1, v18
    v_lshlrev_b32 v20, 1, v18
    v_and_b32 v20, 2, v20
    v_or_b32 v19, v19, v20
    v_bfe_u32 v20, v1, 4, 1
    v_bfe_u32 v21, v1, 2, 2
    v_lshl_add_u32 v22, v17, 3, v21
    s_cmp_eq_u32 s60, 0
    s_cselect_b64 vcc, -1, 0
    s_lshl_b32 s34, s56, 3
    v_cndmask_b32 v23, v18, v19, vcc
    v_lshl_add_u32 v23, v20, 2, v23
    v_add_u32 v23, s34, v23
    v_lshlrev_b32 v24, 2, v21
    v_and_b32 v24, 8, v24
    v_xor_b32 v23, v23, v24
    v_lshlrev_b32 v23, 3, v23
    v_lshl_add_u32 v4, v22, 7, v23
    v_add_u32 v122, 98304, v4
    s_lshl_b32 s35, s60, 13
    s_add_u32 s35, s35, 8192
    v_add_u32 v4, s35, v4
    v_add_u32 v5, 49152, v4
    v_mov_b32 v23, 1073741824

    s_cmp_lg_u32 s60, 0
    s_cbranch_scc1 L_vtype_4

    v_and_b32 v18, 0x13, v16
    v_lshlrev_b32 v19, 1, v16
    v_and_b32 v19, 8, v19
    v_lshrrev_b32 v20, 1, v16
    v_and_b32 v20, 4, v20
    v_or3_b32 v18, v18, v19, v20
    v_lshlrev_b32 v18, 4, v18
    v_mov_b32 v74, 0x3f803f80
    v_mov_b32 v75, 0x3f80
    v_mov_b32 v30, 0x3f803f80
    v_mov_b32 v31, 0x3f80
    s_add_u32 s59, s54, 4194304
    s_lshl_b32 s34, s58, 2

    v_add_u32 v19, s34, v17
    v_add_u32 v19, 0, v19
    v_mul_u32_u24 v20, 37, v19
    v_lshrrev_b32 v20, 8, v20
    v_mul_u32_u24 v21, 7, v20
    v_sub_u32 v22, v19, v21
    v_cmp_eq_u32 s[36:37], 3, v22
    v_lshl_add_u32 v76, v20, 19, v18
    v_lshrrev_b32 v21, 2, v22
    v_lshl_add_u32 v76, v21, 18, v76
    v_and_b32 v21, 3, v22
    v_lshl_add_u32 v76, v21, 9, v76
    v_add_u32 v21, 0x40000, v76
    v_cndmask_b32 v78, v23, v21, s[36:37]

    v_add_u32 v19, s34, v17
    v_add_u32 v19, 2, v19
    v_mul_u32_u24 v20, 37, v19
    v_lshrrev_b32 v20, 8, v20
    v_mul_u32_u24 v21, 7, v20
    v_sub_u32 v22, v19, v21
    v_cmp_eq_u32 s[38:39], 3, v22
    v_lshl_add_u32 v77, v20, 19, v18
    v_lshrrev_b32 v21, 2, v22
    v_lshl_add_u32 v77, v21, 18, v77
    v_and_b32 v21, 3, v22
    v_lshl_add_u32 v77, v21, 9, v77
    v_add_u32 v21, 0x40000, v77
    v_cndmask_b32 v79, v23, v21, s[38:39]

    s_waitcnt vmcnt(3) lgkmcnt(0)
    s_barrier
    ds_read_b64_tr_b16 v[48:49], v4 offset:0
    ds_read_b64_tr_b16 v[50:51], v4 offset:512
    ds_read_b128 v[128:131], v8 offset:0
    ds_read_b64_tr_b16 v[52:53], v4 offset:2048
    ds_read_b64_tr_b16 v[54:55], v4 offset:2560
    ds_read_b128 v[132:135], v9 offset:0
    ds_read_b64_tr_b16 v[56:57], v4 offset:4096
    ds_read_b64_tr_b16 v[58:59], v4 offset:4608
    ds_read_b128 v[136:139], v10 offset:0
    ds_read_b64_tr_b16 v[60:61], v4 offset:6144
    ds_read_b64_tr_b16 v[62:63], v4 offset:6656
    ds_read_b128 v[140:143], v11 offset:0
    s_lshl_b32 s47, s46, 7
    s_add_u32 s47, s47, s51
    s_add_u32 m0, s50, 49152
    s_mul_i32 s48, s46, 172032
    buffer_load_dwordx4 v2, s[8:11], s47 offen lds
    s_add_u32 m0, s50, 56448
    s_add_u32 s48, s48, s49
    buffer_load_dwordx4 v3, s[12:15], s48 offen offset:896 lds
    s_add_u32 m0, s50, 63744
    s_add_u32 s46, s46, 1
    buffer_load_dwordx4 v3, s[12:15], s48 offen offset:1792 lds
    s_cmp_eq_u32 s46, 7
    s_cselect_b32 s46, 0, s46

    s_waitcnt lgkmcnt(9)
    v_mfma_f32_32x32x16_bf16 v[32:47], v[48:51], v[128:131], 0
    s_waitcnt lgkmcnt(6)
    v_mfma_f32_32x32x16_bf16 v[32:47], v[52:55], v[132:135], v[32:47]
    s_waitcnt lgkmcnt(3)
    v_mfma_f32_32x32x16_bf16 v[32:47], v[56:59], v[136:139], v[32:47]
    s_waitcnt lgkmcnt(0)
    v_mfma_f32_32x32x16_bf16 v[32:47], v[60:63], v[140:143], v[32:47]
    s_waitcnt vmcnt(3) lgkmcnt(0)
    s_barrier
    ds_read_b64_tr_b16 v[82:83], v4 offset:24576
    ds_read_b64_tr_b16 v[84:85], v4 offset:25088
    ds_read_b128 v[144:147], v8 offset:24576
    ds_read_b64_tr_b16 v[86:87], v4 offset:26624
    ds_read_b64_tr_b16 v[88:89], v4 offset:27136
    ds_read_b128 v[148:151], v9 offset:24576
    ds_read_b64_tr_b16 v[90:91], v4 offset:28672
    ds_read_b64_tr_b16 v[92:93], v4 offset:29184
    ds_read_b128 v[152:155], v10 offset:24576
    ds_read_b64_tr_b16 v[94:95], v4 offset:30720
    ds_read_b64_tr_b16 v[96:97], v4 offset:31232
    ds_read_b128 v[156:159], v11 offset:24576
    s_lshl_b32 s47, s46, 7
    s_add_u32 s47, s47, s51
    s_add_u32 m0, s50, 73728
    s_mul_i32 s48, s46, 172032
    buffer_load_dwordx4 v2, s[8:11], s47 offen lds
    s_add_u32 m0, s50, 81024
    s_add_u32 s48, s48, s49
    buffer_load_dwordx4 v3, s[12:15], s48 offen offset:896 lds
    s_add_u32 m0, s50, 88320
    s_add_u32 s46, s46, 1
    buffer_load_dwordx4 v3, s[12:15], s48 offen offset:1792 lds
    s_cmp_eq_u32 s46, 7
    s_cselect_b32 s46, 0, s46

    s_waitcnt lgkmcnt(9)
    v_mfma_f32_32x32x16_bf16 v[32:47], v[82:85], v[144:147], v[32:47]
    s_waitcnt lgkmcnt(6)
    v_mfma_f32_32x32x16_bf16 v[32:47], v[86:89], v[148:151], v[32:47]
    s_waitcnt lgkmcnt(3)
    v_mfma_f32_32x32x16_bf16 v[32:47], v[90:93], v[152:155], v[32:47]
    s_waitcnt lgkmcnt(0)
    v_mfma_f32_32x32x16_bf16 v[32:47], v[94:97], v[156:159], v[32:47]
    s_waitcnt vmcnt(3) lgkmcnt(0)
    s_barrier
    ds_read_b64_tr_b16 v[48:49], v5 offset:0
    ds_read_b64_tr_b16 v[50:51], v5 offset:512
    ds_read_b128 v[160:163], v12 offset:0
    ds_read_b64_tr_b16 v[52:53], v5 offset:2048
    ds_read_b64_tr_b16 v[54:55], v5 offset:2560
    ds_read_b128 v[164:167], v13 offset:0
    ds_read_b64_tr_b16 v[56:57], v5 offset:4096
    ds_read_b64_tr_b16 v[58:59], v5 offset:4608
    ds_read_b128 v[168:171], v14 offset:0
    ds_read_b64_tr_b16 v[60:61], v5 offset:6144
    ds_read_b64_tr_b16 v[62:63], v5 offset:6656
    ds_read_b128 v[172:175], v15 offset:0
    s_lshl_b32 s47, s46, 7
    s_add_u32 s47, s47, s51
    s_add_u32 m0, s50, 0
    s_mul_i32 s48, s46, 172032
    buffer_load_dwordx4 v2, s[8:11], s47 offen lds
    s_add_u32 m0, s50, 7296
    s_add_u32 s48, s48, s49
    buffer_load_dwordx4 v3, s[12:15], s48 offen offset:896 lds
    s_add_u32 m0, s50, 14592
    s_add_u32 s46, s46, 1
    buffer_load_dwordx4 v3, s[12:15], s48 offen offset:1792 lds
    s_cmp_eq_u32 s46, 7
    s_cselect_b32 s46, 0, s46

    s_waitcnt lgkmcnt(9)
    v_mfma_f32_32x32x16_bf16 v[32:47], v[48:51], v[160:163], v[32:47]
    s_waitcnt lgkmcnt(6)
    v_mfma_f32_32x32x16_bf16 v[32:47], v[52:55], v[164:167], v[32:47]
    s_waitcnt lgkmcnt(3)
    v_mfma_f32_32x32x16_bf16 v[32:47], v[56:59], v[168:171], v[32:47]
    s_waitcnt lgkmcnt(0)
    v_mfma_f32_32x32x16_bf16 v[32:47], v[60:63], v[172:175], v[32:47]
    s_waitcnt vmcnt(3) lgkmcnt(0)
    s_barrier
    ds_read_b64_tr_b16 v[82:83], v5 offset:24576
    ds_read_b64_tr_b16 v[84:85], v5 offset:25088
    ds_read_b128 v[176:179], v12 offset:24576
    ds_read_b64_tr_b16 v[86:87], v5 offset:26624
    ds_read_b64_tr_b16 v[88:89], v5 offset:27136
    ds_read_b128 v[180:183], v13 offset:24576
    ds_read_b64_tr_b16 v[90:91], v5 offset:28672
    ds_read_b64_tr_b16 v[92:93], v5 offset:29184
    ds_read_b128 v[184:187], v14 offset:24576
    ds_read_b64_tr_b16 v[94:95], v5 offset:30720
    ds_read_b64_tr_b16 v[96:97], v5 offset:31232
    ds_read_b128 v[188:191], v15 offset:24576
    s_lshl_b32 s47, s46, 7
    s_add_u32 s47, s47, s51
    s_add_u32 m0, s50, 24576
    s_mul_i32 s48, s46, 172032
    buffer_load_dwordx4 v2, s[8:11], s47 offen lds
    s_add_u32 m0, s50, 31872
    s_add_u32 s48, s48, s49
    buffer_load_dwordx4 v3, s[12:15], s48 offen offset:896 lds
    s_add_u32 m0, s50, 39168
    s_add_u32 s46, s46, 1
    buffer_load_dwordx4 v3, s[12:15], s48 offen offset:1792 lds
    s_cmp_eq_u32 s46, 7
    s_cselect_b32 s46, 0, s46

    buffer_load_dwordx2 v[80:81], v7, s[4:7], 0 offen sc1
    s_waitcnt lgkmcnt(9)
    v_mfma_f32_32x32x16_bf16 v[32:47], v[82:85], v[176:179], v[32:47]
    s_waitcnt lgkmcnt(6)
    v_mfma_f32_32x32x16_bf16 v[32:47], v[86:89], v[180:183], v[32:47]
    s_waitcnt lgkmcnt(3)
    v_mfma_f32_32x32x16_bf16 v[32:47], v[90:93], v[184:187], v[32:47]
    s_waitcnt lgkmcnt(0)
    v_mfma_f32_32x32x16_bf16 v[32:47], v[94:97], v[188:191], v[32:47]
    s_waitcnt vmcnt(4) lgkmcnt(0)
    s_barrier
    ds_read_b64_tr_b16 v[48:49], v4 offset:0
    ds_read_b64_tr_b16 v[50:51], v4 offset:512
    ds_read_b128 v[192:195], v8 offset:0
    ds_read_b64_tr_b16 v[52:53], v4 offset:2048
    ds_read_b64_tr_b16 v[54:55], v4 offset:2560
    ds_read_b128 v[196:199], v9 offset:0
    ds_read_b64_tr_b16 v[56:57], v4 offset:4096
    ds_read_b64_tr_b16 v[58:59], v4 offset:4608
    ds_read_b128 v[200:203], v10 offset:0
    ds_read_b64_tr_b16 v[60:61], v4 offset:6144
    ds_read_b64_tr_b16 v[62:63], v4 offset:6656
    ds_read_b128 v[204:207], v11 offset:0
    s_lshl_b32 s47, s46, 7
    s_add_u32 s47, s47, s51
    s_add_u32 m0, s50, 49152
    s_mul_i32 s48, s46, 172032
    buffer_load_dwordx4 v2, s[8:11], s47 offen lds
    s_add_u32 m0, s50, 56448
    s_add_u32 s48, s48, s49
    buffer_load_dwordx4 v3, s[12:15], s48 offen offset:896 lds
    s_add_u32 m0, s50, 63744
    s_add_u32 s46, s46, 1
    buffer_load_dwordx4 v3, s[12:15], s48 offen offset:1792 lds
    s_cmp_eq_u32 s46, 7
    s_cselect_b32 s46, 0, s46

    s_waitcnt lgkmcnt(9)
    v_mfma_f32_32x32x16_bf16 v[32:47], v[48:51], v[192:195], v[32:47]
    s_waitcnt lgkmcnt(6)
    v_mfma_f32_32x32x16_bf16 v[32:47], v[52:55], v[196:199], v[32:47]
    s_waitcnt lgkmcnt(3)
    v_mfma_f32_32x32x16_bf16 v[32:47], v[56:59], v[200:203], v[32:47]
    s_waitcnt lgkmcnt(0)
    v_mfma_f32_32x32x16_bf16 v[32:47], v[60:63], v[204:207], v[32:47]
    s_waitcnt vmcnt(4) lgkmcnt(0)
    s_barrier
    ds_read_b64_tr_b16 v[82:83], v4 offset:24576
    ds_read_b64_tr_b16 v[84:85], v4 offset:25088
    ds_read_b128 v[208:211], v8 offset:24576
    ds_read_b64_tr_b16 v[86:87], v4 offset:26624
    ds_read_b64_tr_b16 v[88:89], v4 offset:27136
    ds_read_b128 v[212:215], v9 offset:24576
    ds_read_b64_tr_b16 v[90:91], v4 offset:28672
    ds_read_b64_tr_b16 v[92:93], v4 offset:29184
    ds_read_b128 v[216:219], v10 offset:24576
    ds_read_b64_tr_b16 v[94:95], v4 offset:30720
    ds_read_b64_tr_b16 v[96:97], v4 offset:31232
    ds_read_b128 v[220:223], v11 offset:24576
    s_mul_i32 s48, s46, 172032
    s_add_u32 m0, s50, 98304
    s_add_u32 s48, s48, s49
    buffer_load_dwordx4 v3, s[12:15], s48 offen lds

    s_add_u32 s46, s46, 1
    s_cmp_eq_u32 s46, 7
    s_cselect_b32 s46, 0, s46

    s_mul_i32 s48, s46, 172032
    s_add_u32 m0, s50, 106496
    s_add_u32 s48, s48, s49
    buffer_load_dwordx4 v3, s[12:15], s48 offen lds

    s_add_u32 s46, s46, 1
    s_cmp_eq_u32 s46, 7
    s_cselect_b32 s46, 0, s46

    s_mul_i32 s48, s46, 172032
    s_add_u32 m0, s50, 114688
    s_add_u32 s48, s48, s49
    buffer_load_dwordx4 v3, s[12:15], s48 offen lds

    s_add_u32 s46, s46, 1
    s_cmp_eq_u32 s46, 7
    s_cselect_b32 s46, 0, s46

    s_mul_i32 s48, s46, 172032
    s_add_u32 m0, s50, 122880
    s_add_u32 s48, s48, s49
    buffer_load_dwordx4 v3, s[12:15], s48 offen lds

    s_add_u32 s46, s46, 1
    s_cmp_eq_u32 s46, 7
    s_cselect_b32 s46, 0, s46

    s_waitcnt lgkmcnt(9)
    v_mfma_f32_32x32x16_bf16 v[32:47], v[82:85], v[208:211], v[32:47]
    s_waitcnt lgkmcnt(6)
    v_mfma_f32_32x32x16_bf16 v[32:47], v[86:89], v[212:215], v[32:47]
    s_waitcnt lgkmcnt(3)
    v_mfma_f32_32x32x16_bf16 v[32:47], v[90:93], v[216:219], v[32:47]
    s_waitcnt lgkmcnt(0)
    v_mfma_f32_32x32x16_bf16 v[32:47], v[94:97], v[220:223], v[32:47]
    s_waitcnt vmcnt(4) lgkmcnt(0)
    s_barrier
    ds_read_b64_tr_b16 v[48:49], v5 offset:0
    ds_read_b64_tr_b16 v[50:51], v5 offset:512
    ds_read_b128 v[224:227], v12 offset:0
    ds_read_b64_tr_b16 v[52:53], v5 offset:2048
    ds_read_b64_tr_b16 v[54:55], v5 offset:2560
    ds_read_b128 v[228:231], v13 offset:0
    ds_read_b64_tr_b16 v[56:57], v5 offset:4096
    ds_read_b64_tr_b16 v[58:59], v5 offset:4608
    ds_read_b128 v[232:235], v14 offset:0
    ds_read_b64_tr_b16 v[60:61], v5 offset:6144
    ds_read_b64_tr_b16 v[62:63], v5 offset:6656
    ds_read_b128 v[236:239], v15 offset:0
    s_mul_i32 s48, s46, 172032
    s_add_u32 m0, s50, 131072
    s_add_u32 s48, s48, s49
    buffer_load_dwordx4 v3, s[12:15], s48 offen lds

    s_add_u32 s46, s46, 1
    s_cmp_eq_u32 s46, 7
    s_cselect_b32 s46, 0, s46

    s_mul_i32 s48, s46, 172032
    s_add_u32 m0, s50, 139264
    s_add_u32 s48, s48, s49
    buffer_load_dwordx4 v3, s[12:15], s48 offen lds

    s_add_u32 s46, s46, 1
    s_cmp_eq_u32 s46, 7
    s_cselect_b32 s46, 0, s46

    s_mul_i32 s48, s46, 172032
    s_add_u32 m0, s50, 147456
    s_add_u32 s48, s48, s49
    buffer_load_dwordx4 v3, s[12:15], s48 offen lds

    s_add_u32 s46, s46, 1
    s_cmp_eq_u32 s46, 7
    s_cselect_b32 s46, 0, s46

    s_waitcnt lgkmcnt(9)
    v_mfma_f32_32x32x16_bf16 v[32:47], v[48:51], v[224:227], v[32:47]
    s_waitcnt lgkmcnt(6)
    v_mfma_f32_32x32x16_bf16 v[32:47], v[52:55], v[228:231], v[32:47]
    s_waitcnt lgkmcnt(3)
    v_mfma_f32_32x32x16_bf16 v[32:47], v[56:59], v[232:235], v[32:47]
    s_waitcnt lgkmcnt(0)
    v_mfma_f32_32x32x16_bf16 v[32:47], v[60:63], v[236:239], v[32:47]
    s_waitcnt vmcnt(3)
    s_barrier
    ds_read_b64_tr_b16 v[48:49], v122 offset:0
    ds_read_b64_tr_b16 v[50:51], v122 offset:512
    ds_read_b64_tr_b16 v[52:53], v122 offset:2048
    ds_read_b64_tr_b16 v[54:55], v122 offset:2560
    ds_read_b64_tr_b16 v[56:57], v122 offset:4096
    ds_read_b64_tr_b16 v[58:59], v122 offset:4608
    ds_read_b64_tr_b16 v[60:61], v122 offset:6144
    ds_read_b64_tr_b16 v[62:63], v122 offset:6656
    ds_read_b64_tr_b16 v[82:83], v122 offset:8192
    ds_read_b64_tr_b16 v[84:85], v122 offset:8704
    s_waitcnt lgkmcnt(8)
    v_mfma_f32_32x32x16_bf16 v[98:113], v[48:51], v[128:131], 0
    ds_read_b64_tr_b16 v[86:87], v122 offset:10240
    ds_read_b64_tr_b16 v[88:89], v122 offset:10752
    s_waitcnt lgkmcnt(8)
    v_mfma_f32_32x32x16_bf16 v[98:113], v[52:55], v[132:135], v[98:113]
    v_cvt_pk_bf16_f32 v64, v32, v33
    v_cvt_pk_bf16_f32 v65, v34, v35
    v_cvt_pk_bf16_f32 v66, v36, v37
    v_cvt_pk_bf16_f32 v67, v38, v39
    ds_read_b64_tr_b16 v[90:91], v122 offset:12288
    ds_read_b64_tr_b16 v[92:93], v122 offset:12800
    s_waitcnt lgkmcnt(8)
    v_mfma_f32_32x32x16_bf16 v[98:113], v[56:59], v[136:139], v[98:113]
    v_mov_b32 v72, v66
    v_mov_b32 v73, v67
    v_cndmask_b32 v66, v66, v74, s[36:37]
    v_cndmask_b32 v67, v67, v75, s[36:37]
    ds_read_b64_tr_b16 v[94:95], v122 offset:14336
    ds_read_b64_tr_b16 v[96:97], v122 offset:14848
    s_waitcnt lgkmcnt(8)
    v_mfma_f32_32x32x16_bf16 v[98:113], v[60:63], v[140:143], v[98:113]
    v_cvt_pk_bf16_f32 v68, v40, v41
    v_cvt_pk_bf16_f32 v69, v42, v43
    v_cvt_pk_bf16_f32 v70, v44, v45
    v_cvt_pk_bf16_f32 v71, v46, v47
    ds_read_b64_tr_b16 v[48:49], v122 offset:16384
    ds_read_b64_tr_b16 v[50:51], v122 offset:16896
    s_waitcnt lgkmcnt(8)
    v_mfma_f32_32x32x16_bf16 v[98:113], v[82:85], v[144:147], v[98:113]
    v_mov_b32 v28, v70
    v_mov_b32 v29, v71
    v_cndmask_b32 v70, v70, v74, s[38:39]
    v_cndmask_b32 v71, v71, v75, s[38:39]
    ds_read_b64_tr_b16 v[52:53], v122 offset:18432
    ds_read_b64_tr_b16 v[54:55], v122 offset:18944
    s_waitcnt lgkmcnt(8)
    v_mfma_f32_32x32x16_bf16 v[98:113], v[86:89], v[148:151], v[98:113]
    buffer_store_dwordx4 v[64:67], v76, s[16:19], s54 offen sc1
    ds_read_b64_tr_b16 v[56:57], v122 offset:20480
    ds_read_b64_tr_b16 v[58:59], v122 offset:20992
    s_waitcnt lgkmcnt(8)
    v_mfma_f32_32x32x16_bf16 v[98:113], v[90:93], v[152:155], v[98:113]
    buffer_store_dwordx4 v[72:75], v78, s[16:19], s54 offen sc1
    ds_read_b64_tr_b16 v[60:61], v122 offset:22528
    ds_read_b64_tr_b16 v[62:63], v122 offset:23040
    s_waitcnt lgkmcnt(8)
    v_mfma_f32_32x32x16_bf16 v[98:113], v[94:97], v[156:159], v[98:113]
    buffer_store_dwordx4 v[68:71], v77, s[16:19], s54 offen sc1
    ds_read_b64_tr_b16 v[82:83], v122 offset:24576
    ds_read_b64_tr_b16 v[84:85], v122 offset:25088
    s_waitcnt lgkmcnt(8)
    v_mfma_f32_32x32x16_bf16 v[98:113], v[48:51], v[160:163], v[98:113]
    buffer_store_dwordx4 v[28:31], v79, s[16:19], s54 offen sc1
    ds_read_b64_tr_b16 v[86:87], v122 offset:26624
    ds_read_b64_tr_b16 v[88:89], v122 offset:27136
    s_waitcnt lgkmcnt(8)
    v_mfma_f32_32x32x16_bf16 v[98:113], v[52:55], v[164:167], v[98:113]
    ds_read_b64_tr_b16 v[90:91], v122 offset:28672
    ds_read_b64_tr_b16 v[92:93], v122 offset:29184
    s_waitcnt lgkmcnt(8)
    v_mfma_f32_32x32x16_bf16 v[98:113], v[56:59], v[168:171], v[98:113]
    ds_read_b64_tr_b16 v[94:95], v122 offset:30720
    ds_read_b64_tr_b16 v[96:97], v122 offset:31232
    s_waitcnt lgkmcnt(8)
    v_mfma_f32_32x32x16_bf16 v[98:113], v[60:63], v[172:175], v[98:113]
    s_waitcnt vmcnt(4)
    s_barrier
    ds_read_b64_tr_b16 v[48:49], v122 offset:32768
    ds_read_b64_tr_b16 v[50:51], v122 offset:33280
    s_waitcnt lgkmcnt(8)
    v_mfma_f32_32x32x16_bf16 v[98:113], v[82:85], v[176:179], v[98:113]
    ds_read_b64_tr_b16 v[52:53], v122 offset:34816
    ds_read_b64_tr_b16 v[54:55], v122 offset:35328
    s_waitcnt lgkmcnt(8)
    v_mfma_f32_32x32x16_bf16 v[98:113], v[86:89], v[180:183], v[98:113]
    ds_read_b64_tr_b16 v[56:57], v122 offset:36864
    ds_read_b64_tr_b16 v[58:59], v122 offset:37376
    s_waitcnt lgkmcnt(8)
    v_mfma_f32_32x32x16_bf16 v[98:113], v[90:93], v[184:187], v[98:113]
    ds_read_b64_tr_b16 v[60:61], v122 offset:38912
    ds_read_b64_tr_b16 v[62:63], v122 offset:39424
    s_waitcnt lgkmcnt(8)
    v_mfma_f32_32x32x16_bf16 v[98:113], v[94:97], v[188:191], v[98:113]
    ds_read_b64_tr_b16 v[82:83], v122 offset:40960
    ds_read_b64_tr_b16 v[84:85], v122 offset:41472
    s_waitcnt lgkmcnt(8)
    v_mfma_f32_32x32x16_bf16 v[98:113], v[48:51], v[192:195], v[98:113]
    ds_read_b64_tr_b16 v[86:87], v122 offset:43008
    ds_read_b64_tr_b16 v[88:89], v122 offset:43520
    s_waitcnt lgkmcnt(8)
    v_mfma_f32_32x32x16_bf16 v[98:113], v[52:55], v[196:199], v[98:113]
    ds_read_b64_tr_b16 v[90:91], v122 offset:45056
    ds_read_b64_tr_b16 v[92:93], v122 offset:45568
    s_waitcnt lgkmcnt(8)
    v_mfma_f32_32x32x16_bf16 v[98:113], v[56:59], v[200:203], v[98:113]
    ds_read_b64_tr_b16 v[94:95], v122 offset:47104
    ds_read_b64_tr_b16 v[96:97], v122 offset:47616
    s_waitcnt lgkmcnt(8)
    v_mfma_f32_32x32x16_bf16 v[98:113], v[60:63], v[204:207], v[98:113]
    ds_read_b64_tr_b16 v[48:49], v122 offset:49152
    ds_read_b64_tr_b16 v[50:51], v122 offset:49664
    s_waitcnt lgkmcnt(8)
    v_mfma_f32_32x32x16_bf16 v[98:113], v[82:85], v[208:211], v[98:113]
    v_mov_b32 v74, 0
    v_mov_b32 v75, 0
    v_mov_b32 v30, 0
    v_mov_b32 v31, 0
    s_mov_b32 s34, 0x3e8b97f6
    ds_read_b64_tr_b16 v[52:53], v122 offset:51200
    ds_read_b64_tr_b16 v[54:55], v122 offset:51712
    s_waitcnt lgkmcnt(8)
    v_mfma_f32_32x32x16_bf16 v[98:113], v[86:89], v[212:215], v[98:113]
    ds_read_b64_tr_b16 v[56:57], v122 offset:53248
    ds_read_b64_tr_b16 v[58:59], v122 offset:53760
    s_waitcnt lgkmcnt(8)
    v_mfma_f32_32x32x16_bf16 v[98:113], v[90:93], v[216:219], v[98:113]
    ds_read_b64_tr_b16 v[60:61], v122 offset:55296
    ds_read_b64_tr_b16 v[62:63], v122 offset:55808
    s_waitcnt lgkmcnt(8)
    v_mfma_f32_32x32x16_bf16 v[98:113], v[94:97], v[220:223], v[98:113]
    s_waitcnt lgkmcnt(6)
    v_mfma_f32_32x32x16_bf16 v[98:113], v[48:51], v[224:227], v[98:113]
    s_waitcnt lgkmcnt(4)
    v_mfma_f32_32x32x16_bf16 v[98:113], v[52:55], v[228:231], v[98:113]
    s_waitcnt lgkmcnt(2)
    v_mfma_f32_32x32x16_bf16 v[98:113], v[56:59], v[232:235], v[98:113]
    s_waitcnt lgkmcnt(0)
    v_mfma_f32_32x32x16_bf16 v[98:113], v[60:63], v[236:239], v[98:113]
    s_nop 11
    v_pk_mul_f32 v[98:99], v[98:99], s[34:35] op_sel_hi:[1,0]
    v_pk_mul_f32 v[100:101], v[100:101], s[34:35] op_sel_hi:[1,0]
    v_pk_mul_f32 v[102:103], v[102:103], s[34:35] op_sel_hi:[1,0]
    v_pk_mul_f32 v[104:105], v[104:105], s[34:35] op_sel_hi:[1,0]
    v_cvt_pk_bf16_f32 v64, v98, v99
    v_cvt_pk_bf16_f32 v65, v100, v101
    v_cvt_pk_bf16_f32 v66, v102, v103
    v_cvt_pk_bf16_f32 v67, v104, v105
    v_mov_b32 v72, v66
    v_mov_b32 v73, v67
    v_cndmask_b32 v66, v66, v74, s[36:37]
    v_cndmask_b32 v67, v67, v75, s[36:37]
    buffer_store_dwordx4 v[64:67], v76, s[16:19], s59 offen sc1
    buffer_store_dwordx4 v[72:75], v78, s[16:19], s59 offen sc1
    v_pk_mul_f32 v[106:107], v[106:107], s[34:35] op_sel_hi:[1,0]
    v_pk_mul_f32 v[108:109], v[108:109], s[34:35] op_sel_hi:[1,0]
    v_pk_mul_f32 v[110:111], v[110:111], s[34:35] op_sel_hi:[1,0]
    v_pk_mul_f32 v[112:113], v[112:113], s[34:35] op_sel_hi:[1,0]
    v_cvt_pk_bf16_f32 v68, v106, v107
    v_cvt_pk_bf16_f32 v69, v108, v109
    v_cvt_pk_bf16_f32 v70, v110, v111
    v_cvt_pk_bf16_f32 v71, v112, v113
    v_mov_b32 v28, v70
    v_mov_b32 v29, v71
    v_cndmask_b32 v70, v70, v74, s[38:39]
    v_cndmask_b32 v71, v71, v75, s[38:39]
    buffer_store_dwordx4 v[68:71], v77, s[16:19], s59 offen sc1
    buffer_store_dwordx4 v[28:31], v79, s[16:19], s59 offen sc1
    s_branch L_pub_5
L_vtype_4:
    s_lshl_b32 s34, s58, 5
    v_add_u32 v18, s34, v16
    v_mul_u32_u24 v19, 2341, v18
    v_lshrrev_b32 v19, 16, v19
    v_mul_u32_u24 v20, 28, v19
    v_sub_u32 v22, v18, v20
    v_lshl_add_u32 v20, v17, 5, v22
    v_lshlrev_b32 v20, 4, v20
    v_lshl_add_u32 v76, v19, 18, v20
    v_cmp_eq_u32 vcc, 0, v22
    v_mov_b32 v21, 0x3f803f80
    s_nop 0
    v_cndmask_b32 v72, 0, v21, vcc
    v_cndmask_b32 v73, 0, v21, vcc
    v_cndmask_b32 v74, 0, v21, vcc
    v_cndmask_b32 v75, 0, v21, vcc
    v_cmp_gt_u32 vcc, 4, v22
    s_nop 1
    v_cndmask_b32 v77, v23, v76, vcc

    s_waitcnt vmcnt(3) lgkmcnt(0)
    s_barrier
    ds_read_b64_tr_b16 v[48:49], v4 offset:0
    ds_read_b64_tr_b16 v[50:51], v4 offset:512
    ds_read_b128 v[128:131], v8 offset:0
    ds_read_b64_tr_b16 v[52:53], v4 offset:2048
    ds_read_b64_tr_b16 v[54:55], v4 offset:2560
    ds_read_b128 v[132:135], v9 offset:0
    ds_read_b64_tr_b16 v[56:57], v4 offset:4096
    ds_read_b64_tr_b16 v[58:59], v4 offset:4608
    ds_read_b128 v[136:139], v10 offset:0
    ds_read_b64_tr_b16 v[60:61], v4 offset:6144
    ds_read_b64_tr_b16 v[62:63], v4 offset:6656
    ds_read_b128 v[140:143], v11 offset:0
    s_lshl_b32 s47, s46, 7
    s_add_u32 s47, s47, s51
    s_add_u32 m0, s50, 49152
    s_mul_i32 s48, s46, 172032
    buffer_load_dwordx4 v2, s[8:11], s47 offen lds
    s_add_u32 m0, s50, 56448
    s_add_u32 s48, s48, s49
    buffer_load_dwordx4 v3, s[12:15], s48 offen offset:896 lds
    s_add_u32 m0, s50, 63744
    s_add_u32 s46, s46, 1
    buffer_load_dwordx4 v3, s[12:15], s48 offen offset:1792 lds
    s_cmp_eq_u32 s46, 7
    s_cselect_b32 s46, 0, s46

    s_waitcnt lgkmcnt(9)
    v_mfma_f32_32x32x16_bf16 v[32:47], v[128:131], v[48:51], 0
    s_waitcnt lgkmcnt(6)
    v_mfma_f32_32x32x16_bf16 v[32:47], v[132:135], v[52:55], v[32:47]
    s_waitcnt lgkmcnt(3)
    v_mfma_f32_32x32x16_bf16 v[32:47], v[136:139], v[56:59], v[32:47]
    s_waitcnt lgkmcnt(0)
    v_mfma_f32_32x32x16_bf16 v[32:47], v[140:143], v[60:63], v[32:47]
    s_waitcnt vmcnt(3) lgkmcnt(0)
    s_barrier
    ds_read_b64_tr_b16 v[82:83], v4 offset:24576
    ds_read_b64_tr_b16 v[84:85], v4 offset:25088
    ds_read_b128 v[144:147], v8 offset:24576
    ds_read_b64_tr_b16 v[86:87], v4 offset:26624
    ds_read_b64_tr_b16 v[88:89], v4 offset:27136
    ds_read_b128 v[148:151], v9 offset:24576
    ds_read_b64_tr_b16 v[90:91], v4 offset:28672
    ds_read_b64_tr_b16 v[92:93], v4 offset:29184
    ds_read_b128 v[152:155], v10 offset:24576
    ds_read_b64_tr_b16 v[94:95], v4 offset:30720
    ds_read_b64_tr_b16 v[96:97], v4 offset:31232
    ds_read_b128 v[156:159], v11 offset:24576
    s_lshl_b32 s47, s46, 7
    s_add_u32 s47, s47, s51
    s_add_u32 m0, s50, 73728
    s_mul_i32 s48, s46, 172032
    buffer_load_dwordx4 v2, s[8:11], s47 offen lds
    s_add_u32 m0, s50, 81024
    s_add_u32 s48, s48, s49
    buffer_load_dwordx4 v3, s[12:15], s48 offen offset:896 lds
    s_add_u32 m0, s50, 88320
    s_add_u32 s46, s46, 1
    buffer_load_dwordx4 v3, s[12:15], s48 offen offset:1792 lds
    s_cmp_eq_u32 s46, 7
    s_cselect_b32 s46, 0, s46

    s_waitcnt lgkmcnt(9)
    v_mfma_f32_32x32x16_bf16 v[32:47], v[144:147], v[82:85], v[32:47]
    s_waitcnt lgkmcnt(6)
    v_mfma_f32_32x32x16_bf16 v[32:47], v[148:151], v[86:89], v[32:47]
    s_waitcnt lgkmcnt(3)
    v_mfma_f32_32x32x16_bf16 v[32:47], v[152:155], v[90:93], v[32:47]
    s_waitcnt lgkmcnt(0)
    v_mfma_f32_32x32x16_bf16 v[32:47], v[156:159], v[94:97], v[32:47]
    s_waitcnt vmcnt(3) lgkmcnt(0)
    s_barrier
    ds_read_b64_tr_b16 v[48:49], v5 offset:0
    ds_read_b64_tr_b16 v[50:51], v5 offset:512
    ds_read_b128 v[160:163], v12 offset:0
    ds_read_b64_tr_b16 v[52:53], v5 offset:2048
    ds_read_b64_tr_b16 v[54:55], v5 offset:2560
    ds_read_b128 v[164:167], v13 offset:0
    ds_read_b64_tr_b16 v[56:57], v5 offset:4096
    ds_read_b64_tr_b16 v[58:59], v5 offset:4608
    ds_read_b128 v[168:171], v14 offset:0
    ds_read_b64_tr_b16 v[60:61], v5 offset:6144
    ds_read_b64_tr_b16 v[62:63], v5 offset:6656
    ds_read_b128 v[172:175], v15 offset:0
    s_lshl_b32 s47, s46, 7
    s_add_u32 s47, s47, s51
    s_add_u32 m0, s50, 0
    s_mul_i32 s48, s46, 172032
    buffer_load_dwordx4 v2, s[8:11], s47 offen lds
    s_add_u32 m0, s50, 7296
    s_add_u32 s48, s48, s49
    buffer_load_dwordx4 v3, s[12:15], s48 offen offset:896 lds
    s_add_u32 m0, s50, 14592
    s_add_u32 s46, s46, 1
    buffer_load_dwordx4 v3, s[12:15], s48 offen offset:1792 lds
    s_cmp_eq_u32 s46, 7
    s_cselect_b32 s46, 0, s46

    s_waitcnt lgkmcnt(9)
    v_mfma_f32_32x32x16_bf16 v[32:47], v[160:163], v[48:51], v[32:47]
    s_waitcnt lgkmcnt(6)
    v_mfma_f32_32x32x16_bf16 v[32:47], v[164:167], v[52:55], v[32:47]
    s_waitcnt lgkmcnt(3)
    v_mfma_f32_32x32x16_bf16 v[32:47], v[168:171], v[56:59], v[32:47]
    s_waitcnt lgkmcnt(0)
    v_mfma_f32_32x32x16_bf16 v[32:47], v[172:175], v[60:63], v[32:47]
    s_waitcnt vmcnt(3) lgkmcnt(0)
    s_barrier
    ds_read_b64_tr_b16 v[82:83], v5 offset:24576
    ds_read_b64_tr_b16 v[84:85], v5 offset:25088
    ds_read_b128 v[176:179], v12 offset:24576
    ds_read_b64_tr_b16 v[86:87], v5 offset:26624
    ds_read_b64_tr_b16 v[88:89], v5 offset:27136
    ds_read_b128 v[180:183], v13 offset:24576
    ds_read_b64_tr_b16 v[90:91], v5 offset:28672
    ds_read_b64_tr_b16 v[92:93], v5 offset:29184
    ds_read_b128 v[184:187], v14 offset:24576
    ds_read_b64_tr_b16 v[94:95], v5 offset:30720
    ds_read_b64_tr_b16 v[96:97], v5 offset:31232
    ds_read_b128 v[188:191], v15 offset:24576
    s_lshl_b32 s47, s46, 7
    s_add_u32 s47, s47, s51
    s_add_u32 m0, s50, 24576
    s_mul_i32 s48, s46, 172032
    buffer_load_dwordx4 v2, s[8:11], s47 offen lds
    s_add_u32 m0, s50, 31872
    s_add_u32 s48, s48, s49
    buffer_load_dwordx4 v3, s[12:15], s48 offen offset:896 lds
    s_add_u32 m0, s50, 39168
    s_add_u32 s46, s46, 1
    buffer_load_dwordx4 v3, s[12:15], s48 offen offset:1792 lds
    s_cmp_eq_u32 s46, 7
    s_cselect_b32 s46, 0, s46

    buffer_load_dwordx2 v[80:81], v7, s[4:7], 0 offen sc1
    s_waitcnt lgkmcnt(9)
    v_mfma_f32_32x32x16_bf16 v[32:47], v[176:179], v[82:85], v[32:47]
    s_waitcnt lgkmcnt(6)
    v_mfma_f32_32x32x16_bf16 v[32:47], v[180:183], v[86:89], v[32:47]
    s_waitcnt lgkmcnt(3)
    v_mfma_f32_32x32x16_bf16 v[32:47], v[184:187], v[90:93], v[32:47]
    s_waitcnt lgkmcnt(0)
    v_mfma_f32_32x32x16_bf16 v[32:47], v[188:191], v[94:97], v[32:47]
    s_waitcnt vmcnt(4) lgkmcnt(0)
    s_barrier
    ds_read_b64_tr_b16 v[48:49], v4 offset:0
    ds_read_b64_tr_b16 v[50:51], v4 offset:512
    ds_read_b128 v[192:195], v8 offset:0
    ds_read_b64_tr_b16 v[52:53], v4 offset:2048
    ds_read_b64_tr_b16 v[54:55], v4 offset:2560
    ds_read_b128 v[196:199], v9 offset:0
    ds_read_b64_tr_b16 v[56:57], v4 offset:4096
    ds_read_b64_tr_b16 v[58:59], v4 offset:4608
    ds_read_b128 v[200:203], v10 offset:0
    ds_read_b64_tr_b16 v[60:61], v4 offset:6144
    ds_read_b64_tr_b16 v[62:63], v4 offset:6656
    ds_read_b128 v[204:207], v11 offset:0
    s_lshl_b32 s47, s46, 7
    s_add_u32 s47, s47, s51
    s_add_u32 m0, s50, 49152
    s_mul_i32 s48, s46, 172032
    buffer_load_dwordx4 v2, s[8:11], s47 offen lds
    s_add_u32 m0, s50, 56448
    s_add_u32 s48, s48, s49
    buffer_load_dwordx4 v3, s[12:15], s48 offen offset:896 lds
    s_add_u32 m0, s50, 63744
    s_add_u32 s46, s46, 1
    buffer_load_dwordx4 v3, s[12:15], s48 offen offset:1792 lds
    s_cmp_eq_u32 s46, 7
    s_cselect_b32 s46, 0, s46

    s_waitcnt lgkmcnt(9)
    v_mfma_f32_32x32x16_bf16 v[32:47], v[192:195], v[48:51], v[32:47]
    s_waitcnt lgkmcnt(6)
    v_mfma_f32_32x32x16_bf16 v[32:47], v[196:199], v[52:55], v[32:47]
    s_waitcnt lgkmcnt(3)
    v_mfma_f32_32x32x16_bf16 v[32:47], v[200:203], v[56:59], v[32:47]
    s_waitcnt lgkmcnt(0)
    v_mfma_f32_32x32x16_bf16 v[32:47], v[204:207], v[60:63], v[32:47]
    s_waitcnt vmcnt(4) lgkmcnt(0)
    s_barrier
    ds_read_b64_tr_b16 v[82:83], v4 offset:24576
    ds_read_b64_tr_b16 v[84:85], v4 offset:25088
    ds_read_b128 v[208:211], v8 offset:24576
    ds_read_b64_tr_b16 v[86:87], v4 offset:26624
    ds_read_b64_tr_b16 v[88:89], v4 offset:27136
    ds_read_b128 v[212:215], v9 offset:24576
    ds_read_b64_tr_b16 v[90:91], v4 offset:28672
    ds_read_b64_tr_b16 v[92:93], v4 offset:29184
    ds_read_b128 v[216:219], v10 offset:24576
    ds_read_b64_tr_b16 v[94:95], v4 offset:30720
    ds_read_b64_tr_b16 v[96:97], v4 offset:31232
    ds_read_b128 v[220:223], v11 offset:24576
    s_mul_i32 s48, s46, 172032
    s_add_u32 m0, s50, 98304
    s_add_u32 s48, s48, s49
    buffer_load_dwordx4 v3, s[12:15], s48 offen lds

    s_add_u32 s46, s46, 1
    s_cmp_eq_u32 s46, 7
    s_cselect_b32 s46, 0, s46

    s_mul_i32 s48, s46, 172032
    s_add_u32 m0, s50, 106496
    s_add_u32 s48, s48, s49
    buffer_load_dwordx4 v3, s[12:15], s48 offen lds

    s_add_u32 s46, s46, 1
    s_cmp_eq_u32 s46, 7
    s_cselect_b32 s46, 0, s46

    s_mul_i32 s48, s46, 172032
    s_add_u32 m0, s50, 114688
    s_add_u32 s48, s48, s49
    buffer_load_dwordx4 v3, s[12:15], s48 offen lds

    s_add_u32 s46, s46, 1
    s_cmp_eq_u32 s46, 7
    s_cselect_b32 s46, 0, s46

    s_mul_i32 s48, s46, 172032
    s_add_u32 m0, s50, 122880
    s_add_u32 s48, s48, s49
    buffer_load_dwordx4 v3, s[12:15], s48 offen lds

    s_add_u32 s46, s46, 1
    s_cmp_eq_u32 s46, 7
    s_cselect_b32 s46, 0, s46

    s_waitcnt lgkmcnt(9)
    v_mfma_f32_32x32x16_bf16 v[32:47], v[208:211], v[82:85], v[32:47]
    s_waitcnt lgkmcnt(6)
    v_mfma_f32_32x32x16_bf16 v[32:47], v[212:215], v[86:89], v[32:47]
    s_waitcnt lgkmcnt(3)
    v_mfma_f32_32x32x16_bf16 v[32:47], v[216:219], v[90:93], v[32:47]
    s_waitcnt lgkmcnt(0)
    v_mfma_f32_32x32x16_bf16 v[32:47], v[220:223], v[94:97], v[32:47]
    s_waitcnt vmcnt(4) lgkmcnt(0)
    s_barrier
    ds_read_b64_tr_b16 v[48:49], v5 offset:0
    ds_read_b64_tr_b16 v[50:51], v5 offset:512
    ds_read_b128 v[224:227], v12 offset:0
    ds_read_b64_tr_b16 v[52:53], v5 offset:2048
    ds_read_b64_tr_b16 v[54:55], v5 offset:2560
    ds_read_b128 v[228:231], v13 offset:0
    ds_read_b64_tr_b16 v[56:57], v5 offset:4096
    ds_read_b64_tr_b16 v[58:59], v5 offset:4608
    ds_read_b128 v[232:235], v14 offset:0
    ds_read_b64_tr_b16 v[60:61], v5 offset:6144
    ds_read_b64_tr_b16 v[62:63], v5 offset:6656
    ds_read_b128 v[236:239], v15 offset:0
    s_mul_i32 s48, s46, 172032
    s_add_u32 m0, s50, 131072
    s_add_u32 s48, s48, s49
    buffer_load_dwordx4 v3, s[12:15], s48 offen lds

    s_add_u32 s46, s46, 1
    s_cmp_eq_u32 s46, 7
    s_cselect_b32 s46, 0, s46

    s_mul_i32 s48, s46, 172032
    s_add_u32 m0, s50, 139264
    s_add_u32 s48, s48, s49
    buffer_load_dwordx4 v3, s[12:15], s48 offen lds

    s_add_u32 s46, s46, 1
    s_cmp_eq_u32 s46, 7
    s_cselect_b32 s46, 0, s46

    s_mul_i32 s48, s46, 172032
    s_add_u32 m0, s50, 147456
    s_add_u32 s48, s48, s49
    buffer_load_dwordx4 v3, s[12:15], s48 offen lds

    s_add_u32 s46, s46, 1
    s_cmp_eq_u32 s46, 7
    s_cselect_b32 s46, 0, s46

    s_waitcnt lgkmcnt(9)
    v_mfma_f32_32x32x16_bf16 v[32:47], v[224:227], v[48:51], v[32:47]
    s_waitcnt lgkmcnt(6)
    v_mfma_f32_32x32x16_bf16 v[32:47], v[228:231], v[52:55], v[32:47]
    s_waitcnt lgkmcnt(3)
    v_mfma_f32_32x32x16_bf16 v[32:47], v[232:235], v[56:59], v[32:47]
    s_waitcnt lgkmcnt(0)
    v_mfma_f32_32x32x16_bf16 v[32:47], v[236:239], v[60:63], v[32:47]
    s_waitcnt vmcnt(3)
    s_barrier
    s_nop 9
    v_cvt_pk_bf16_f32 v64, v32, v33
    v_cvt_pk_bf16_f32 v65, v34, v35
    v_cvt_pk_bf16_f32 v66, v36, v37
    v_cvt_pk_bf16_f32 v67, v38, v39
    v_cvt_pk_bf16_f32 v68, v40, v41
    v_cvt_pk_bf16_f32 v69, v42, v43
    v_cvt_pk_bf16_f32 v70, v44, v45
    v_cvt_pk_bf16_f32 v71, v46, v47
    buffer_store_dwordx4 v[64:67], v76, s[16:19], s54 offen offset:2048 sc1
    buffer_store_dwordx4 v[68:71], v76, s[16:19], s54 offen offset:3072 sc1
    buffer_store_dwordx4 v[72:75], v77, s[16:19], s54 offen offset:2496 sc1
    buffer_store_dwordx4 v[72:75], v77, s[16:19], s54 offen offset:3520 sc1
    s_waitcnt vmcnt(4)
    s_barrier
L_pub_5:
    s_waitcnt vmcnt(0)
    v_readfirstlane_b32 s34, v80
    s_mov_b32 s35, 0
    s_sub_u32 s58, s62, s34
    s_cmp_lt_i32 s58, 1000
    s_cselect_b32 s34, s34, 0
    s_cmp_lg_u32 s34, 0
    s_cbranch_scc1 L_ngot_6
L_nwait_7:
    s_sleep 4
    buffer_load_dwordx2 v[80:81], v7, s[4:7], 0 offen sc1
    s_waitcnt vmcnt(0)
    v_readfirstlane_b32 s34, v80
    s_add_u32 s35, s35, 1
    s_cmp_ge_u32 s35, 262144
    s_cbranch_scc1 L_ngot_6
    s_cmp_ge_u32 s35, 256
    s_cbranch_scc1 L_nz_8
    s_sub_u32 s58, s62, s34
    s_cmp_lt_i32 s58, 1000
    s_cselect_b32 s34, s34, 0
L_nz_8:
    s_cmp_eq_u32 s34, 0
    s_cbranch_scc1 L_nwait_7
L_ngot_6:

    s_barrier
    buffer_store_dwordx2 v[80:81], v6, s[16:19], s57 offen sc1

    s_cmp_lg_u32 s31, 7
    s_cbranch_scc1 L_sync1_2
    s_mul_i32 s34, s32, 28
    s_add_u32 s35, s34, 27
    s_lshr_b32 s34, s34, 6
    s_lshr_b32 s35, s35, 6
    v_mov_b32 v16, s34
    s_mov_b32 exec_lo, 0
    v_mov_b32 v16, s35
    s_mov_b32 exec_lo, -1
    v_cmp_eq_u32 vcc, 3, v16
    s_nop 1
    v_cndmask_b32 v17, v16, v1, vcc
    v_and_b32 v17, 4, v17
    v_and_b32 v16, 3, v16
    v_lshl_add_u32 v16, v16, 6, v17
    v_bfe_u32 v17, v1, 3, 2
    v_add_u32 v16, v16, v17
    v_and_b32 v17, 7, v1
    v_lshl_add_u32 v16, v17, 3, v16
    v_lshlrev_b32 v16, 7, v16
    s_mov_b32 s35, 0
    s_cmp_lg_u32 s55, 7
    s_cbranch_scc1 L_h_12
    s_xor_b32 s34, s2, 4
    s_lshl_b32 s34, s34, 7
    s_add_u32 s34, s34, 10518528
L_h_11:
    s_sleep 4
    buffer_load_dwordx2 v[240:241], v7, s[16:19], s34 offen sc1
    s_add_u32 s35, s35, 1
    s_waitcnt vmcnt(0)
    v_cmp_ne_u64 vcc, v[240:241], v[80:81]
    s_cmp_ge_u32 s35, 262144
    s_cbranch_scc1 L_h_13
    s_cmp_lg_u64 vcc, 0
    s_cbranch_scc1 L_h_11
    s_branch L_h_13
L_h_12:
    s_waitcnt vmcnt(0)
    s_sleep 10
L_h_13:

L_poll1_9:
    buffer_load_dwordx2 v[240:241], v16, s[16:19], s41 offen sc1
    s_waitcnt vmcnt(0)
    v_cmp_ne_u64 vcc, v[240:241], v[80:81]
    s_nop 0
    s_cmp_eq_u64 vcc, 0
    s_cbranch_scc1 L_sync1_2
    s_sleep 4

    s_add_u32 s35, s35, 1
    s_cmp_lt_u32 s35, 262144
    s_cbranch_scc1 L_poll1_9

L_sync1_2:
    s_lshl_b32 s34, s60, 5
    s_add_u32 s34, s34, s61
    s_lshl_b32 s34, s34, 12
    s_lshl_b32 s51, s32, 18
    s_add_u32 s46, s51, s34
    s_lshl_b32 s48, s53, 12
    s_add_u32 s48, s48, s51
    s_lshl_b32 s34, s60, 10
    s_add_u32 s48, s48, s34
    s_add_u32 s48, s48, 4194304
    s_lshl_b32 s35, s61, 11
    s_add_u32 s34, s34, s35
    s_add_u32 m0, s34, 98304
    s_lshl_b32 s47, s31, 12
    s_lshl_b32 s34, s60, 12
    s_and_b32 s35, s31, 1
    s_lshl_b32 s35, s35, 10
    s_add_u32 s34, s34, s35
    s_bfe_u32 s35, s31, 0x10001
    s_lshl_b32 s50, s35, 14
    s_add_u32 s50, s50, s34
    s_lshl_b32 s35, s35, 17
    s_add_u32 s51, s51, s35
    s_add_u32 s51, s51, s34
    s_barrier

    buffer_load_dwordx4 v123, s[16:19], s48 offen sc1 lds
    s_mov_b32 m0, s50
    s_add_u32 s35, s51, 8192
    buffer_load_dwordx4 v123, s[16:19], s51 offen sc1 lds
    s_barrier
    buffer_load_dwordx4 v123, s[16:19], s51 offen offset:2048 sc1 lds
    s_add_u32 m0, s50, 8192
    s_nop 0
    buffer_load_dwordx4 v123, s[16:19], s35 offen sc1 lds
    buffer_load_dwordx4 v123, s[16:19], s35 offen offset:2048 sc1 lds

    s_lshl_b32 s34, s60, 14
    v_add_u32 v3, s34, v123
    v_add_u32 v4, 0x10000, v3
    v_mov_b32 v5, 0xdddddddd
    v_lshrrev_b32 v16, 3, v0
    v_lshrrev_b32 v17, 3, v1
    v_and_b32 v17, 6, v17
    v_and_b32 v18, 7, v1
    v_xor_b32 v17, v17, v18
    v_mul_u32_u24 v176, 896, v16
    v_lshl_add_u32 v176, v17, 4, v176
    v_mov_b32 v177, 1073741824
    s_lshr_b32 s49, s2, 5
    s_min_u32 s49, s49, 6
    s_lshl_b32 s49, s49, 7
    s_lshl_b32 s54, s31, 10
    s_add_u32 s57, s57, 262144
    s_mov_b32 s41, 10747904
    s_and_b32 s34, s2, 7
    s_lshl_b32 s34, s34, 2
    s_bfe_u32 s35, s2, 0x20003
    s_add_u32 s52, s34, s35
    s_lshr_b32 s34, s52, 1
    s_lshl_b32 s34, s34, 3
    s_lshl_b32 s35, s60, 2
    s_add_u32 s34, s34, s35
    v_bfe_u32 v16, v1, 1, 2
    v_add_u32 v16, s34, v16
    v_and_b32 v17, 1, v1
    v_lshl_add_u32 v16, v17, 7, v16
    v_lshlrev_b32 v178, 7, v16

    v_mov_b32 v82, 0
    v_mov_b32 v83, 0
    v_mov_b32 v84, 0
    v_mov_b32 v85, 0
    v_mov_b32 v86, 0
    v_mov_b32 v87, 0
    v_mov_b32 v88, 0
    v_mov_b32 v89, 0
    v_mov_b32 v90, 0
    v_mov_b32 v91, 0
    v_mov_b32 v92, 0
    v_mov_b32 v93, 0
    v_mov_b32 v94, 0
    v_mov_b32 v95, 0
    v_mov_b32 v96, 0
    v_mov_b32 v97, 0
    s_lshl_b32 s34, s61, 11
    s_add_u32 s34, s34, 98304
    v_add_u32 v106, s34, v123
    s_waitcnt vmcnt(3)
    s_barrier
    ds_read_b128 v[98:101], v106
    ds_read_b128 v[160:163], v123
    ds_read_b128 v[102:105], v106 offset:1024
    ds_read_b128 v[164:167], v123 offset:1024

    ds_read_b128 v[128:131], v3 offset:0
    ds_read_b128 v[132:135], v3 offset:1024
    ds_read_b128 v[136:139], v3 offset:4096
    ds_read_b128 v[140:143], v3 offset:5120
    s_waitcnt lgkmcnt(6)
    v_mfma_f32_32x32x16_bf16 v[64:79], v[160:163], v[98:101], 0
    s_waitcnt lgkmcnt(4)
    v_mfma_f32_32x32x16_bf16 v[64:79], v[164:167], v[102:105], v[64:79]
    s_waitcnt lgkmcnt(3)
    v_mfma_f32_32x32x16_bf16 v[32:47], v[128:131], v[98:101], 0
    s_add_u32 m0, s47, 32768
    s_add_u32 s46, s46, 16384
    buffer_load_dwordx4 v123, s[16:19], s46 offen offset:0 sc1 lds
    buffer_load_dwordx4 v123, s[16:19], s46 offen offset:1024 sc1 lds
    buffer_load_dwordx4 v123, s[16:19], s46 offen offset:2048 sc1 lds
    buffer_load_dwordx4 v123, s[16:19], s46 offen offset:3072 sc1 lds
    s_nop 3
    v_max3_f32 v16, v64, v65, v66
    v_max3_f32 v17, v67, v68, v69
    v_max3_f32 v16, v16, v70, v71
    v_max3_f32 v17, v17, v72, v73
    v_max3_f32 v16, v16, v74, v75
    v_max3_f32 v17, v17, v76, v77
    v_max3_f32 v16, v16, v78, v79
    v_max_f32 v16, v16, v17
    v_mov_b32 v17, v16
    s_nop 1
    v_permlane32_swap_b32 v16, v17
    v_max_f32 v16, v16, v17
    s_mov_b32 exec_lo, 0
    v_cvt_pk_bf16_f32 v104, -v16, 0
    s_mov_b32 exec_lo, -1
    s_waitcnt lgkmcnt(0)

    v_mfma_f32_32x32x16_bf16 v[32:47], v[132:135], v[102:105], v[32:47]
    s_waitcnt vmcnt(4)
    s_barrier
    ds_read_b128 v[144:147], v3 offset:2048
    ds_read_b128 v[148:151], v3 offset:3072
    ds_read_b128 v[152:155], v3 offset:6144
    ds_read_b128 v[156:159], v3 offset:7168
    ds_read_b128 v[128:131], v3 offset:8192
    ds_read_b128 v[132:135], v3 offset:9216
    s_nop 1
    v_mfma_f32_32x32x16_bf16 v[48:63], v[136:139], v[98:101], 0
    s_add_u32 s46, s46, 16384
    ds_read_b128 v[160:163], v3 offset:10240
    v_exp_f32 v32, v32
    v_exp_f32 v33, v33
    v_exp_f32 v34, v34
    v_exp_f32 v35, v35
    v_mfma_f32_32x32x16_bf16 v[48:63], v[140:143], v[102:105], v[48:63]
    s_add_u32 m0, s47, 65536
    ds_read_b128 v[164:167], v3 offset:11264
    v_exp_f32 v36, v36
    v_exp_f32 v37, v37
    v_exp_f32 v38, v38
    v_exp_f32 v39, v39
    s_setprio 0
    buffer_load_dwordx4 v123, s[16:19], s46 offen offset:0 sc1 lds
    ds_read_b128 v[136:139], v3 offset:12288
    v_exp_f32 v40, v40
    v_exp_f32 v41, v41
    v_exp_f32 v42, v42
    v_exp_f32 v43, v43
    s_waitcnt lgkmcnt(5)
    v_smfmac_f32_32x32x32_bf16 v[82:97], v[144:147], v[32:39], v5
    s_waitcnt lgkmcnt(3)
    buffer_load_dwordx4 v123, s[16:19], s46 offen offset:1024 sc1 lds
    ds_read_b128 v[140:143], v3 offset:13312
    v_exp_f32 v44, v44
    v_exp_f32 v45, v45
    v_exp_f32 v46, v46
    v_exp_f32 v47, v47
    v_mfma_f32_32x32x16_bf16 v[64:79], v[128:131], v[98:101], 0
    ds_read_b128 v[168:171], v3 offset:14336
    v_exp_f32 v48, v48
    v_exp_f32 v49, v49
    v_exp_f32 v50, v50
    v_exp_f32 v51, v51
    v_mfma_f32_32x32x16_bf16 v[64:79], v[132:135], v[102:105], v[64:79]
    ds_read_b128 v[172:175], v3 offset:15360
    v_exp_f32 v52, v52
    v_exp_f32 v53, v53
    v_exp_f32 v54, v54
    v_exp_f32 v55, v55
    v_smfmac_f32_32x32x32_bf16 v[82:97], v[148:151], v[40:47], v5
    s_waitcnt vmcnt(2) lgkmcnt(0)
    s_barrier
    s_setprio 3
    buffer_load_dwordx4 v123, s[16:19], s46 offen offset:2048 sc1 lds
    ds_read_b128 v[128:131], v3 offset:32768
    v_exp_f32 v56, v56
    v_exp_f32 v57, v57
    v_exp_f32 v58, v58
    v_exp_f32 v59, v59
    v_smfmac_f32_32x32x32_bf16 v[82:97], v[152:155], v[48:55], v5
    s_waitcnt lgkmcnt(3)
    buffer_load_dwordx4 v123, s[16:19], s46 offen offset:3072 sc1 lds
    ds_read_b128 v[132:135], v3 offset:33792
    v_exp_f32 v60, v60
    v_exp_f32 v61, v61
    v_exp_f32 v62, v62
    v_exp_f32 v63, v63
    v_mfma_f32_32x32x16_bf16 v[32:47], v[136:139], v[98:101], 0
    s_add_u32 s46, s46, 16384
    ds_read_b128 v[144:147], v3 offset:34816
    v_exp_f32 v64, v64
    v_exp_f32 v65, v65
    v_exp_f32 v66, v66
    v_exp_f32 v67, v67
    v_mfma_f32_32x32x16_bf16 v[32:47], v[140:143], v[102:105], v[32:47]
    s_add_u32 m0, s47, 0
    ds_read_b128 v[148:151], v3 offset:35840
    v_exp_f32 v68, v68
    v_exp_f32 v69, v69
    v_exp_f32 v70, v70
    v_exp_f32 v71, v71
    v_smfmac_f32_32x32x32_bf16 v[82:97], v[156:159], v[56:63], v5
    s_setprio 2
    buffer_load_dwordx4 v123, s[16:19], s46 offen offset:0 sc1 lds
    ds_read_b128 v[136:139], v3 offset:36864
    v_exp_f32 v72, v72
    v_exp_f32 v73, v73
    v_exp_f32 v74, v74
    v_exp_f32 v75, v75
    v_smfmac_f32_32x32x32_bf16 v[82:97], v[160:163], v[64:71], v5
    s_waitcnt lgkmcnt(3)
    buffer_load_dwordx4 v123, s[16:19], s46 offen offset:1024 sc1 lds
    ds_read_b128 v[140:143], v3 offset:37888
    v_exp_f32 v76, v76
    v_exp_f32 v77, v77
    v_exp_f32 v78, v78
    v_exp_f32 v79, v79
    v_mfma_f32_32x32x16_bf16 v[48:63], v[128:131], v[98:101], 0
    ds_read_b128 v[152:155], v3 offset:38912
    v_exp_f32 v32, v32
    v_exp_f32 v33, v33
    v_exp_f32 v34, v34
    v_exp_f32 v35, v35
    v_mfma_f32_32x32x16_bf16 v[48:63], v[132:135], v[102:105], v[48:63]
    ds_read_b128 v[156:159], v3 offset:39936
    v_exp_f32 v36, v36
    v_exp_f32 v37, v37
    v_exp_f32 v38, v38
    v_exp_f32 v39, v39
    v_smfmac_f32_32x32x32_bf16 v[82:97], v[164:167], v[72:79], v5
    s_setprio 1
    ds_read_b128 v[128:131], v3 offset:40960
    v_exp_f32 v40, v40
    v_exp_f32 v41, v41
    v_exp_f32 v42, v42
    v_exp_f32 v43, v43
    v_smfmac_f32_32x32x32_bf16 v[82:97], v[168:171], v[32:39], v5
    s_waitcnt lgkmcnt(3)
    buffer_load_dwordx4 v123, s[16:19], s46 offen offset:2048 sc1 lds
    ds_read_b128 v[132:135], v3 offset:41984
    v_exp_f32 v44, v44
    v_exp_f32 v45, v45
    v_exp_f32 v46, v46
    v_exp_f32 v47, v47
    v_mfma_f32_32x32x16_bf16 v[64:79], v[136:139], v[98:101], 0
    ds_read_b128 v[160:163], v3 offset:43008
    v_exp_f32 v48, v48
    v_exp_f32 v49, v49
    v_exp_f32 v50, v50
    v_exp_f32 v51, v51
    v_mfma_f32_32x32x16_bf16 v[64:79], v[140:143], v[102:105], v[64:79]
    ds_read_b128 v[164:167], v3 offset:44032
    v_exp_f32 v52, v52
    v_exp_f32 v53, v53
    v_exp_f32 v54, v54
    v_exp_f32 v55, v55
    v_smfmac_f32_32x32x32_bf16 v[82:97], v[172:175], v[40:47], v5
    s_setprio 0
    ds_read_b128 v[136:139], v3 offset:45056
    v_exp_f32 v56, v56
    v_exp_f32 v57, v57
    v_exp_f32 v58, v58
    v_exp_f32 v59, v59
    v_smfmac_f32_32x32x32_bf16 v[82:97], v[144:147], v[48:55], v5
    s_waitcnt lgkmcnt(3)
    buffer_load_dwordx4 v123, s[16:19], s46 offen offset:3072 sc1 lds
    ds_read_b128 v[140:143], v3 offset:46080
    v_exp_f32 v60, v60
    v_exp_f32 v61, v61
    v_exp_f32 v62, v62
    v_exp_f32 v63, v63
    v_mfma_f32_32x32x16_bf16 v[32:47], v[128:131], v[98:101], 0
    s_add_u32 s46, s46, 16384
    ds_read_b128 v[168:171], v3 offset:47104
    v_exp_f32 v64, v64
    v_exp_f32 v65, v65
    v_exp_f32 v66, v66
    v_exp_f32 v67, v67
    v_mfma_f32_32x32x16_bf16 v[32:47], v[132:135], v[102:105], v[32:47]
    s_add_u32 m0, s47, 32768
    ds_read_b128 v[172:175], v3 offset:48128
    v_exp_f32 v68, v68
    v_exp_f32 v69, v69
    v_exp_f32 v70, v70
    v_exp_f32 v71, v71
    v_smfmac_f32_32x32x32_bf16 v[82:97], v[148:151], v[56:63], v5
    s_waitcnt vmcnt(4) lgkmcnt(0)
    s_barrier
    s_setprio 3
    ds_read_b128 v[128:131], v4 offset:0
    v_exp_f32 v72, v72
    v_exp_f32 v73, v73
    v_exp_f32 v74, v74
    v_exp_f32 v75, v75
    v_smfmac_f32_32x32x32_bf16 v[82:97], v[152:155], v[64:71], v5
    s_waitcnt lgkmcnt(3)
    buffer_load_dwordx4 v123, s[16:19], s46 offen offset:0 sc1 lds
    ds_read_b128 v[132:135], v4 offset:1024
    v_exp_f32 v76, v76
    v_exp_f32 v77, v77
    v_exp_f32 v78, v78
    v_exp_f32 v79, v79
    v_mfma_f32_32x32x16_bf16 v[48:63], v[136:139], v[98:101], 0
    ds_read_b128 v[144:147], v4 offset:2048
    v_exp_f32 v32, v32
    v_exp_f32 v33, v33
    v_exp_f32 v34, v34
    v_exp_f32 v35, v35
    v_mfma_f32_32x32x16_bf16 v[48:63], v[140:143], v[102:105], v[48:63]
    ds_read_b128 v[148:151], v4 offset:3072
    v_exp_f32 v36, v36
    v_exp_f32 v37, v37
    v_exp_f32 v38, v38
    v_exp_f32 v39, v39
    v_smfmac_f32_32x32x32_bf16 v[82:97], v[156:159], v[72:79], v5
    s_setprio 2
    ds_read_b128 v[136:139], v4 offset:4096
    v_exp_f32 v40, v40
    v_exp_f32 v41, v41
    v_exp_f32 v42, v42
    v_exp_f32 v43, v43
    v_smfmac_f32_32x32x32_bf16 v[82:97], v[160:163], v[32:39], v5
    s_waitcnt lgkmcnt(3)
    buffer_load_dwordx4 v123, s[16:19], s46 offen offset:1024 sc1 lds
    ds_read_b128 v[140:143], v4 offset:5120
    buffer_store_dwordx4 v[124:127], v123, s[16:19], s40 offen sc1
    v_exp_f32 v44, v44
    v_exp_f32 v45, v45
    v_exp_f32 v46, v46
    v_exp_f32 v47, v47
    v_mfma_f32_32x32x16_bf16 v[64:79], v[128:131], v[98:101], 0
    ds_read_b128 v[152:155], v4 offset:6144
    v_exp_f32 v48, v48
    v_exp_f32 v49, v49
    v_exp_f32 v50, v50
    v_exp_f32 v51, v51
    v_mfma_f32_32x32x16_bf16 v[64:79], v[132:135], v[102:105], v[64:79]
    ds_read_b128 v[156:159], v4 offset:7168
    v_exp_f32 v52, v52
    v_exp_f32 v53, v53
    v_exp_f32 v54, v54
    v_exp_f32 v55, v55
    v_smfmac_f32_32x32x32_bf16 v[82:97], v[164:167], v[40:47], v5
    s_setprio 1
    ds_read_b128 v[128:131], v4 offset:8192
    v_exp_f32 v56, v56
    v_exp_f32 v57, v57
    v_exp_f32 v58, v58
    v_exp_f32 v59, v59
    v_smfmac_f32_32x32x32_bf16 v[82:97], v[168:171], v[48:55], v5
    s_waitcnt lgkmcnt(3)
    buffer_load_dwordx4 v123, s[16:19], s46 offen offset:2048 sc1 lds
    ds_read_b128 v[132:135], v4 offset:9216
    v_exp_f32 v60, v60
    v_exp_f32 v61, v61
    v_exp_f32 v62, v62
    v_exp_f32 v63, v63
    v_mfma_f32_32x32x16_bf16 v[32:47], v[136:139], v[98:101], 0
    ds_read_b128 v[160:163], v4 offset:10240
    v_exp_f32 v64, v64
    v_exp_f32 v65, v65
    v_exp_f32 v66, v66
    v_exp_f32 v67, v67
    v_mfma_f32_32x32x16_bf16 v[32:47], v[140:143], v[102:105], v[32:47]
    ds_read_b128 v[164:167], v4 offset:11264
    v_exp_f32 v68, v68
    v_exp_f32 v69, v69
    v_exp_f32 v70, v70
    v_exp_f32 v71, v71
    v_smfmac_f32_32x32x32_bf16 v[82:97], v[172:175], v[56:63], v5
    s_setprio 0
    ds_read_b128 v[136:139], v4 offset:12288
    v_exp_f32 v72, v72
    v_exp_f32 v73, v73
    v_exp_f32 v74, v74
    v_exp_f32 v75, v75
    v_smfmac_f32_32x32x32_bf16 v[82:97], v[144:147], v[64:71], v5
    s_waitcnt lgkmcnt(3)
    buffer_load_dwordx4 v123, s[16:19], s46 offen offset:3072 sc1 lds
    ds_read_b128 v[140:143], v4 offset:13312
    v_exp_f32 v76, v76
    v_exp_f32 v77, v77
    v_exp_f32 v78, v78
    v_exp_f32 v79, v79
    v_mfma_f32_32x32x16_bf16 v[48:63], v[128:131], v[98:101], 0
    s_add_u32 s46, s46, 16384
    ds_read_b128 v[168:171], v4 offset:14336
    v_exp_f32 v32, v32
    v_exp_f32 v33, v33
    v_exp_f32 v34, v34
    v_exp_f32 v35, v35
    v_mfma_f32_32x32x16_bf16 v[48:63], v[132:135], v[102:105], v[48:63]
    s_add_u32 m0, s47, 65536
    ds_read_b128 v[172:175], v4 offset:15360
    v_exp_f32 v36, v36
    v_exp_f32 v37, v37
    v_exp_f32 v38, v38
    v_exp_f32 v39, v39
    v_smfmac_f32_32x32x32_bf16 v[82:97], v[148:151], v[72:79], v5
    s_waitcnt vmcnt(5) lgkmcnt(0)
    s_barrier
    s_setprio 3
    ds_read_b128 v[128:131], v3 offset:0
    v_exp_f32 v40, v40
    v_exp_f32 v41, v41
    v_exp_f32 v42, v42
    v_exp_f32 v43, v43
    v_smfmac_f32_32x32x32_bf16 v[82:97], v[152:155], v[32:39], v5
    s_waitcnt lgkmcnt(3)
    buffer_load_dwordx4 v123, s[16:19], s46 offen offset:0 sc1 lds
    ds_read_b128 v[132:135], v3 offset:1024
    v_exp_f32 v44, v44
    v_exp_f32 v45, v45
    v_exp_f32 v46, v46
    v_exp_f32 v47, v47
    v_mfma_f32_32x32x16_bf16 v[64:79], v[136:139], v[98:101], 0
    ds_read_b128 v[144:147], v3 offset:2048
    v_exp_f32 v48, v48
    v_exp_f32 v49, v49
    v_exp_f32 v50, v50
    v_exp_f32 v51, v51
    v_mfma_f32_32x32x16_bf16 v[64:79], v[140:143], v[102:105], v[64:79]
    ds_read_b128 v[148:151], v3 offset:3072
    v_exp_f32 v52, v52
    v_exp_f32 v53, v53
    v_exp_f32 v54, v54
    v_exp_f32 v55, v55
    v_smfmac_f32_32x32x32_bf16 v[82:97], v[156:159], v[40:47], v5
    s_setprio 2
    ds_read_b128 v[136:139], v3 offset:4096
    v_exp_f32 v56, v56
    v_exp_f32 v57, v57
    v_exp_f32 v58, v58
    v_exp_f32 v59, v59
    v_smfmac_f32_32x32x32_bf16 v[82:97], v[160:163], v[48:55], v5
    s_waitcnt lgkmcnt(3)
    buffer_load_dwordx4 v123, s[16:19], s46 offen offset:1024 sc1 lds
    ds_read_b128 v[140:143], v3 offset:5120
    v_exp_f32 v60, v60
    v_exp_f32 v61, v61
    v_exp_f32 v62, v62
    v_exp_f32 v63, v63
    v_mfma_f32_32x32x16_bf16 v[32:47], v[128:131], v[98:101], 0
    ds_read_b128 v[152:155], v3 offset:6144
    v_exp_f32 v64, v64
    v_exp_f32 v65, v65
    v_exp_f32 v66, v66
    v_exp_f32 v67, v67
    v_mfma_f32_32x32x16_bf16 v[32:47], v[132:135], v[102:105], v[32:47]
    ds_read_b128 v[156:159], v3 offset:7168
    v_exp_f32 v68, v68
    v_exp_f32 v69, v69
    v_exp_f32 v70, v70
    v_exp_f32 v71, v71
    v_smfmac_f32_32x32x32_bf16 v[82:97], v[164:167], v[56:63], v5
    s_setprio 1
    ds_read_b128 v[128:131], v3 offset:8192
    v_exp_f32 v72, v72
    v_exp_f32 v73, v73
    v_exp_f32 v74, v74
    v_exp_f32 v75, v75
    v_smfmac_f32_32x32x32_bf16 v[82:97], v[168:171], v[64:71], v5
    s_waitcnt lgkmcnt(3)
    buffer_load_dwordx4 v123, s[16:19], s46 offen offset:2048 sc1 lds
    ds_read_b128 v[132:135], v3 offset:9216
    v_exp_f32 v76, v76
    v_exp_f32 v77, v77
    v_exp_f32 v78, v78
    v_exp_f32 v79, v79
    v_mfma_f32_32x32x16_bf16 v[48:63], v[136:139], v[98:101], 0
    ds_read_b128 v[160:163], v3 offset:10240
    v_exp_f32 v32, v32
    v_exp_f32 v33, v33
    v_exp_f32 v34, v34
    v_exp_f32 v35, v35
    v_mfma_f32_32x32x16_bf16 v[48:63], v[140:143], v[102:105], v[48:63]
    ds_read_b128 v[164:167], v3 offset:11264
    v_exp_f32 v36, v36
    v_exp_f32 v37, v37
    v_exp_f32 v38, v38
    v_exp_f32 v39, v39
    v_smfmac_f32_32x32x32_bf16 v[82:97], v[172:175], v[72:79], v5
    s_setprio 0
    ds_read_b128 v[136:139], v3 offset:12288
    v_exp_f32 v40, v40
    v_exp_f32 v41, v41
    v_exp_f32 v42, v42
    v_exp_f32 v43, v43
    v_smfmac_f32_32x32x32_bf16 v[82:97], v[144:147], v[32:39], v5
    s_waitcnt lgkmcnt(3)
    buffer_load_dwordx4 v123, s[16:19], s46 offen offset:3072 sc1 lds
    ds_read_b128 v[140:143], v3 offset:13312
    v_exp_f32 v44, v44
    v_exp_f32 v45, v45
    v_exp_f32 v46, v46
    v_exp_f32 v47, v47
    v_mfma_f32_32x32x16_bf16 v[64:79], v[128:131], v[98:101], 0
    s_add_u32 s46, s46, 16384
    ds_read_b128 v[168:171], v3 offset:14336
    v_exp_f32 v48, v48
    v_exp_f32 v49, v49
    v_exp_f32 v50, v50
    v_exp_f32 v51, v51
    v_mfma_f32_32x32x16_bf16 v[64:79], v[132:135], v[102:105], v[64:79]
    s_add_u32 m0, s47, 0
    ds_read_b128 v[172:175], v3 offset:15360
    v_exp_f32 v52, v52
    v_exp_f32 v53, v53
    v_exp_f32 v54, v54
    v_exp_f32 v55, v55
    v_smfmac_f32_32x32x32_bf16 v[82:97], v[148:151], v[40:47], v5
    s_waitcnt vmcnt(4) lgkmcnt(0)
    s_barrier
    s_setprio 3
    ds_read_b128 v[128:131], v3 offset:32768
    v_exp_f32 v56, v56
    v_exp_f32 v57, v57
    v_exp_f32 v58, v58
    v_exp_f32 v59, v59
    v_smfmac_f32_32x32x32_bf16 v[82:97], v[152:155], v[48:55], v5
    s_waitcnt lgkmcnt(3)
    buffer_load_dwordx4 v123, s[16:19], s46 offen offset:0 sc1 lds
    ds_read_b128 v[132:135], v3 offset:33792
    v_exp_f32 v60, v60
    v_exp_f32 v61, v61
    v_exp_f32 v62, v62
    v_exp_f32 v63, v63
    v_mfma_f32_32x32x16_bf16 v[32:47], v[136:139], v[98:101], 0
    ds_read_b128 v[144:147], v3 offset:34816
    v_exp_f32 v64, v64
    v_exp_f32 v65, v65
    v_exp_f32 v66, v66
    v_exp_f32 v67, v67
    v_mfma_f32_32x32x16_bf16 v[32:47], v[140:143], v[102:105], v[32:47]
    ds_read_b128 v[148:151], v3 offset:35840
    v_exp_f32 v68, v68
    v_exp_f32 v69, v69
    v_exp_f32 v70, v70
    v_exp_f32 v71, v71
    v_smfmac_f32_32x32x32_bf16 v[82:97], v[156:159], v[56:63], v5
    s_setprio 2
    ds_read_b128 v[136:139], v3 offset:36864
    v_exp_f32 v72, v72
    v_exp_f32 v73, v73
    v_exp_f32 v74, v74
    v_exp_f32 v75, v75
    v_smfmac_f32_32x32x32_bf16 v[82:97], v[160:163], v[64:71], v5
    s_waitcnt lgkmcnt(3)
    buffer_load_dwordx4 v123, s[16:19], s46 offen offset:1024 sc1 lds
    ds_read_b128 v[140:143], v3 offset:37888
    v_exp_f32 v76, v76
    v_exp_f32 v77, v77
    v_exp_f32 v78, v78
    v_exp_f32 v79, v79
    v_mfma_f32_32x32x16_bf16 v[48:63], v[128:131], v[98:101], 0
    ds_read_b128 v[152:155], v3 offset:38912
    v_exp_f32 v32, v32
    v_exp_f32 v33, v33
    v_exp_f32 v34, v34
    v_exp_f32 v35, v35
    v_mfma_f32_32x32x16_bf16 v[48:63], v[132:135], v[102:105], v[48:63]
    ds_read_b128 v[156:159], v3 offset:39936
    v_exp_f32 v36, v36
    v_exp_f32 v37, v37
    v_exp_f32 v38, v38
    v_exp_f32 v39, v39
    v_smfmac_f32_32x32x32_bf16 v[82:97], v[164:167], v[72:79], v5
    s_setprio 1
    ds_read_b128 v[128:131], v3 offset:40960
    v_exp_f32 v40, v40
    v_exp_f32 v41, v41
    v_exp_f32 v42, v42
    v_exp_f32 v43, v43
    v_smfmac_f32_32x32x32_bf16 v[82:97], v[168:171], v[32:39], v5
    s_waitcnt lgkmcnt(3)
    buffer_load_dwordx4 v123, s[16:19], s46 offen offset:2048 sc1 lds
    ds_read_b128 v[132:135], v3 offset:41984
    v_exp_f32 v44, v44
    v_exp_f32 v45, v45
    v_exp_f32 v46, v46
    v_exp_f32 v47, v47
    v_mfma_f32_32x32x16_bf16 v[64:79], v[136:139], v[98:101], 0
    ds_read_b128 v[160:163], v3 offset:43008
    v_exp_f32 v48, v48
    v_exp_f32 v49, v49
    v_exp_f32 v50, v50
    v_exp_f32 v51, v51
    v_mfma_f32_32x32x16_bf16 v[64:79], v[140:143], v[102:105], v[64:79]
    ds_read_b128 v[164:167], v3 offset:44032
    v_exp_f32 v52, v52
    v_exp_f32 v53, v53
    v_exp_f32 v54, v54
    v_exp_f32 v55, v55
    v_smfmac_f32_32x32x32_bf16 v[82:97], v[172:175], v[40:47], v5
    s_setprio 0
    ds_read_b128 v[136:139], v3 offset:45056
    v_exp_f32 v56, v56
    v_exp_f32 v57, v57
    v_exp_f32 v58, v58
    v_exp_f32 v59, v59
    v_smfmac_f32_32x32x32_bf16 v[82:97], v[144:147], v[48:55], v5
    s_waitcnt lgkmcnt(3)
    buffer_load_dwordx4 v123, s[16:19], s46 offen offset:3072 sc1 lds
    ds_read_b128 v[140:143], v3 offset:46080
    v_exp_f32 v60, v60
    v_exp_f32 v61, v61
    v_exp_f32 v62, v62
    v_exp_f32 v63, v63
    v_mfma_f32_32x32x16_bf16 v[32:47], v[128:131], v[98:101], 0
    s_add_u32 s46, s46, 16384
    ds_read_b128 v[168:171], v3 offset:47104
    v_exp_f32 v64, v64
    v_exp_f32 v65, v65
    v_exp_f32 v66, v66
    v_exp_f32 v67, v67
    v_mfma_f32_32x32x16_bf16 v[32:47], v[132:135], v[102:105], v[32:47]
    s_add_u32 m0, s47, 32768
    ds_read_b128 v[172:175], v3 offset:48128
    v_exp_f32 v68, v68
    v_exp_f32 v69, v69
    v_exp_f32 v70, v70
    v_exp_f32 v71, v71
    v_smfmac_f32_32x32x32_bf16 v[82:97], v[148:151], v[56:63], v5
    s_waitcnt vmcnt(4) lgkmcnt(0)
    s_barrier
    s_setprio 3
    ds_read_b128 v[128:131], v4 offset:0
    v_exp_f32 v72, v72
    v_exp_f32 v73, v73
    v_exp_f32 v74, v74
    v_exp_f32 v75, v75
    v_smfmac_f32_32x32x32_bf16 v[82:97], v[152:155], v[64:71], v5
    s_waitcnt lgkmcnt(3)
    buffer_load_dwordx4 v123, s[16:19], s46 offen offset:0 sc1 lds
    ds_read_b128 v[132:135], v4 offset:1024
    v_exp_f32 v76, v76
    v_exp_f32 v77, v77
    v_exp_f32 v78, v78
    v_exp_f32 v79, v79
    v_mfma_f32_32x32x16_bf16 v[48:63], v[136:139], v[98:101], 0
    ds_read_b128 v[144:147], v4 offset:2048
    v_exp_f32 v32, v32
    v_exp_f32 v33, v33
    v_exp_f32 v34, v34
    v_exp_f32 v35, v35
    v_mfma_f32_32x32x16_bf16 v[48:63], v[140:143], v[102:105], v[48:63]
    ds_read_b128 v[148:151], v4 offset:3072
    v_exp_f32 v36, v36
    v_exp_f32 v37, v37
    v_exp_f32 v38, v38
    v_exp_f32 v39, v39
    v_smfmac_f32_32x32x32_bf16 v[82:97], v[156:159], v[72:79], v5
    s_setprio 2
    ds_read_b128 v[136:139], v4 offset:4096
    v_exp_f32 v40, v40
    v_exp_f32 v41, v41
    v_exp_f32 v42, v42
    v_exp_f32 v43, v43
    v_smfmac_f32_32x32x32_bf16 v[82:97], v[160:163], v[32:39], v5
    s_waitcnt lgkmcnt(3)
    buffer_load_dwordx4 v123, s[16:19], s46 offen offset:1024 sc1 lds
    ds_read_b128 v[140:143], v4 offset:5120
    v_exp_f32 v44, v44
    v_exp_f32 v45, v45
    v_exp_f32 v46, v46
    v_exp_f32 v47, v47
    v_mfma_f32_32x32x16_bf16 v[64:79], v[128:131], v[98:101], 0
    ds_read_b128 v[152:155], v4 offset:6144
    v_exp_f32 v48, v48
    v_exp_f32 v49, v49
    v_exp_f32 v50, v50
    v_exp_f32 v51, v51
    v_mfma_f32_32x32x16_bf16 v[64:79], v[132:135], v[102:105], v[64:79]
    ds_read_b128 v[156:159], v4 offset:7168
    v_exp_f32 v52, v52
    v_exp_f32 v53, v53
    v_exp_f32 v54, v54
    v_exp_f32 v55, v55
    v_smfmac_f32_32x32x32_bf16 v[82:97], v[164:167], v[40:47], v5
    s_setprio 1
    ds_read_b128 v[128:131], v4 offset:8192
    v_exp_f32 v56, v56
    v_exp_f32 v57, v57
    v_exp_f32 v58, v58
    v_exp_f32 v59, v59
    v_smfmac_f32_32x32x32_bf16 v[82:97], v[168:171], v[48:55], v5
    s_waitcnt lgkmcnt(3)
    buffer_load_dwordx4 v123, s[16:19], s46 offen offset:2048 sc1 lds
    ds_read_b128 v[132:135], v4 offset:9216
    v_exp_f32 v60, v60
    v_exp_f32 v61, v61
    v_exp_f32 v62, v62
    v_exp_f32 v63, v63
    v_mfma_f32_32x32x16_bf16 v[32:47], v[136:139], v[98:101], 0
    ds_read_b128 v[160:163], v4 offset:10240
    v_exp_f32 v64, v64
    v_exp_f32 v65, v65
    v_exp_f32 v66, v66
    v_exp_f32 v67, v67
    v_mfma_f32_32x32x16_bf16 v[32:47], v[140:143], v[102:105], v[32:47]
    ds_read_b128 v[164:167], v4 offset:11264
    v_exp_f32 v68, v68
    v_exp_f32 v69, v69
    v_exp_f32 v70, v70
    v_exp_f32 v71, v71
    v_smfmac_f32_32x32x32_bf16 v[82:97], v[172:175], v[56:63], v5
    s_setprio 0
    ds_read_b128 v[136:139], v4 offset:12288
    v_exp_f32 v72, v72
    v_exp_f32 v73, v73
    v_exp_f32 v74, v74
    v_exp_f32 v75, v75
    v_smfmac_f32_32x32x32_bf16 v[82:97], v[144:147], v[64:71], v5
    s_waitcnt lgkmcnt(3)
    buffer_load_dwordx4 v123, s[16:19], s46 offen offset:3072 sc1 lds
    ds_read_b128 v[140:143], v4 offset:13312
    v_exp_f32 v76, v76
    v_exp_f32 v77, v77
    v_exp_f32 v78, v78
    v_exp_f32 v79, v79
    v_mfma_f32_32x32x16_bf16 v[48:63], v[128:131], v[98:101], 0
    s_add_u32 s34, s49, 0
    ds_read_b128 v[168:171], v4 offset:14336
    v_exp_f32 v32, v32
    v_exp_f32 v33, v33
    v_exp_f32 v34, v34
    v_exp_f32 v35, v35
    v_mfma_f32_32x32x16_bf16 v[48:63], v[132:135], v[102:105], v[48:63]
    s_add_u32 m0, s54, 98304
    ds_read_b128 v[172:175], v4 offset:15360
    v_exp_f32 v36, v36
    v_exp_f32 v37, v37
    v_exp_f32 v38, v38
    v_exp_f32 v39, v39
    v_smfmac_f32_32x32x32_bf16 v[82:97], v[148:151], v[72:79], v5
    s_waitcnt vmcnt(4) lgkmcnt(0)
    s_barrier
    s_setprio 3
    ds_read_b128 v[128:131], v3 offset:0
    v_exp_f32 v40, v40
    v_exp_f32 v41, v41
    v_exp_f32 v42, v42
    v_exp_f32 v43, v43
    v_smfmac_f32_32x32x32_bf16 v[82:97], v[152:155], v[32:39], v5
    s_waitcnt lgkmcnt(3)
    buffer_load_dwordx4 v176, s[20:23], s34 offen lds
    ds_read_b128 v[132:135], v3 offset:1024
    v_exp_f32 v44, v44
    v_exp_f32 v45, v45
    v_exp_f32 v46, v46
    v_exp_f32 v47, v47
    v_mfma_f32_32x32x16_bf16 v[64:79], v[136:139], v[98:101], 0
    s_add_u32 s34, s49, 57344
    ds_read_b128 v[144:147], v3 offset:2048
    v_exp_f32 v48, v48
    v_exp_f32 v49, v49
    v_exp_f32 v50, v50
    v_exp_f32 v51, v51
    v_mfma_f32_32x32x16_bf16 v[64:79], v[140:143], v[102:105], v[64:79]
    s_add_u32 m0, s54, 106496
    ds_read_b128 v[148:151], v3 offset:3072
    v_exp_f32 v52, v52
    v_exp_f32 v53, v53
    v_exp_f32 v54, v54
    v_exp_f32 v55, v55
    v_smfmac_f32_32x32x32_bf16 v[82:97], v[156:159], v[40:47], v5
    s_setprio 2
    ds_read_b128 v[136:139], v3 offset:4096
    v_exp_f32 v56, v56
    v_exp_f32 v57, v57
    v_exp_f32 v58, v58
    v_exp_f32 v59, v59
    v_smfmac_f32_32x32x32_bf16 v[82:97], v[160:163], v[48:55], v5
    s_waitcnt lgkmcnt(3)
    buffer_load_dwordx4 v176, s[20:23], s34 offen lds
    ds_read_b128 v[140:143], v3 offset:5120
    v_exp_f32 v60, v60
    v_exp_f32 v61, v61
    v_exp_f32 v62, v62
    v_exp_f32 v63, v63
    v_mfma_f32_32x32x16_bf16 v[32:47], v[128:131], v[98:101], 0
    s_add_u32 s34, s49, 114688
    ds_read_b128 v[152:155], v3 offset:6144
    v_exp_f32 v64, v64
    v_exp_f32 v65, v65
    v_exp_f32 v66, v66
    v_exp_f32 v67, v67
    v_mfma_f32_32x32x16_bf16 v[32:47], v[132:135], v[102:105], v[32:47]
    s_add_u32 m0, s54, 114688
    ds_read_b128 v[156:159], v3 offset:7168
    v_exp_f32 v68, v68
    v_exp_f32 v69, v69
    v_exp_f32 v70, v70
    v_exp_f32 v71, v71
    v_smfmac_f32_32x32x32_bf16 v[82:97], v[164:167], v[56:63], v5
    s_setprio 1
    ds_read_b128 v[128:131], v3 offset:8192
    v_exp_f32 v72, v72
    v_exp_f32 v73, v73
    v_exp_f32 v74, v74
    v_exp_f32 v75, v75
    v_smfmac_f32_32x32x32_bf16 v[82:97], v[168:171], v[64:71], v5
    s_waitcnt lgkmcnt(3)
    buffer_load_dwordx4 v176, s[20:23], s34 offen lds
    ds_read_b128 v[132:135], v3 offset:9216
    v_exp_f32 v76, v76
    v_exp_f32 v77, v77
    v_exp_f32 v78, v78
    v_exp_f32 v79, v79
    v_mfma_f32_32x32x16_bf16 v[48:63], v[136:139], v[98:101], 0
    s_add_u32 s34, s49, 172032
    ds_read_b128 v[160:163], v3 offset:10240
    v_exp_f32 v32, v32
    v_exp_f32 v33, v33
    v_exp_f32 v34, v34
    v_exp_f32 v35, v35
    v_mfma_f32_32x32x16_bf16 v[48:63], v[140:143], v[102:105], v[48:63]
    s_add_u32 m0, s54, 122880
    ds_read_b128 v[164:167], v3 offset:11264
    v_exp_f32 v36, v36
    v_exp_f32 v37, v37
    v_exp_f32 v38, v38
    v_exp_f32 v39, v39
    v_smfmac_f32_32x32x32_bf16 v[82:97], v[172:175], v[72:79], v5
    s_setprio 0
    ds_read_b128 v[136:139], v3 offset:12288
    v_exp_f32 v40, v40
    v_exp_f32 v41, v41
    v_exp_f32 v42, v42
    v_exp_f32 v43, v43
    v_smfmac_f32_32x32x32_bf16 v[82:97], v[144:147], v[32:39], v5
    s_waitcnt lgkmcnt(3)
    buffer_load_dwordx4 v176, s[20:23], s34 offen lds
    ds_read_b128 v[140:143], v3 offset:13312
    v_exp_f32 v44, v44
    v_exp_f32 v45, v45
    v_exp_f32 v46, v46
    v_exp_f32 v47, v47
    v_mfma_f32_32x32x16_bf16 v[64:79], v[128:131], v[98:101], 0
    s_add_u32 s34, s49, 229376
    ds_read_b128 v[168:171], v3 offset:14336
    v_exp_f32 v48, v48
    v_exp_f32 v49, v49
    v_exp_f32 v50, v50
    v_exp_f32 v51, v51
    v_mfma_f32_32x32x16_bf16 v[64:79], v[132:135], v[102:105], v[64:79]
    s_add_u32 m0, s54, 131072
    ds_read_b128 v[172:175], v3 offset:15360
    v_exp_f32 v52, v52
    v_exp_f32 v53, v53
    v_exp_f32 v54, v54
    v_exp_f32 v55, v55
    v_smfmac_f32_32x32x32_bf16 v[82:97], v[148:151], v[40:47], v5
    s_waitcnt vmcnt(4) lgkmcnt(0)
    s_barrier
    s_setprio 3
    ds_read_b128 v[128:131], v3 offset:32768
    v_exp_f32 v56, v56
    v_exp_f32 v57, v57
    v_exp_f32 v58, v58
    v_exp_f32 v59, v59
    v_smfmac_f32_32x32x32_bf16 v[82:97], v[152:155], v[48:55], v5
    s_waitcnt lgkmcnt(3)
    buffer_load_dwordx4 v176, s[20:23], s34 offen lds
    ds_read_b128 v[132:135], v3 offset:33792
    v_exp_f32 v60, v60
    v_exp_f32 v61, v61
    v_exp_f32 v62, v62
    v_exp_f32 v63, v63
    v_mfma_f32_32x32x16_bf16 v[32:47], v[136:139], v[98:101], 0
    s_add_u32 s34, s49, 286720
    ds_read_b128 v[144:147], v3 offset:34816
    v_exp_f32 v64, v64
    v_exp_f32 v65, v65
    v_exp_f32 v66, v66
    v_exp_f32 v67, v67
    v_mfma_f32_32x32x16_bf16 v[32:47], v[140:143], v[102:105], v[32:47]
    s_add_u32 m0, s54, 139264
    ds_read_b128 v[148:151], v3 offset:35840
    v_exp_f32 v68, v68
    v_exp_f32 v69, v69
    v_exp_f32 v70, v70
    v_exp_f32 v71, v71
    v_smfmac_f32_32x32x32_bf16 v[82:97], v[156:159], v[56:63], v5
    s_setprio 3
    ds_read_b128 v[136:139], v3 offset:36864
    v_exp_f32 v72, v72
    v_exp_f32 v73, v73
    v_exp_f32 v74, v74
    v_exp_f32 v75, v75
    v_smfmac_f32_32x32x32_bf16 v[82:97], v[160:163], v[64:71], v5
    s_waitcnt lgkmcnt(3)
    buffer_load_dwordx4 v176, s[20:23], s34 offen lds
    ds_read_b128 v[140:143], v3 offset:37888
    v_exp_f32 v76, v76
    v_exp_f32 v77, v77
    v_exp_f32 v78, v78
    v_exp_f32 v79, v79
    v_mfma_f32_32x32x16_bf16 v[48:63], v[128:131], v[98:101], 0
    s_add_u32 s34, s49, 344064
    ds_read_b128 v[152:155], v3 offset:38912
    v_exp_f32 v32, v32
    v_exp_f32 v33, v33
    v_exp_f32 v34, v34
    v_exp_f32 v35, v35
    v_mfma_f32_32x32x16_bf16 v[48:63], v[132:135], v[102:105], v[48:63]
    s_add_u32 m0, s54, 147456
    ds_read_b128 v[156:159], v3 offset:39936
    v_exp_f32 v36, v36
    v_exp_f32 v37, v37
    v_exp_f32 v38, v38
    v_exp_f32 v39, v39
    v_smfmac_f32_32x32x32_bf16 v[82:97], v[164:167], v[72:79], v5
    s_setprio 2
    ds_read_b128 v[128:131], v3 offset:40960
    v_exp_f32 v40, v40
    v_exp_f32 v41, v41
    v_exp_f32 v42, v42
    v_exp_f32 v43, v43
    v_smfmac_f32_32x32x32_bf16 v[82:97], v[168:171], v[32:39], v5
    s_waitcnt lgkmcnt(3)
    buffer_load_dwordx4 v176, s[20:23], s34 offen lds
    ds_read_b128 v[132:135], v3 offset:41984
    v_exp_f32 v44, v44
    v_exp_f32 v45, v45
    v_exp_f32 v46, v46
    v_exp_f32 v47, v47
    v_mfma_f32_32x32x16_bf16 v[64:79], v[136:139], v[98:101], 0
    ds_read_b128 v[160:163], v3 offset:43008
    v_exp_f32 v48, v48
    v_exp_f32 v49, v49
    v_exp_f32 v50, v50
    v_exp_f32 v51, v51
    v_mfma_f32_32x32x16_bf16 v[64:79], v[140:143], v[102:105], v[64:79]
    s_add_u32 m0, s54, 155648
    ds_read_b128 v[164:167], v3 offset:44032
    v_exp_f32 v52, v52
    v_exp_f32 v53, v53
    v_exp_f32 v54, v54
    v_exp_f32 v55, v55
    v_smfmac_f32_32x32x32_bf16 v[82:97], v[172:175], v[40:47], v5
    s_setprio 2
    ds_read_b128 v[136:139], v3 offset:45056
    v_exp_f32 v56, v56
    v_exp_f32 v57, v57
    v_exp_f32 v58, v58
    v_exp_f32 v59, v59
    v_smfmac_f32_32x32x32_bf16 v[82:97], v[144:147], v[48:55], v5
    s_waitcnt lgkmcnt(3)
    buffer_load_dwordx4 v177, s[20:23], 0 offen lds
    ds_read_b128 v[140:143], v3 offset:46080
    buffer_store_dwordx2 v[80:81], v6, s[16:19], s57 offen sc1
    v_exp_f32 v60, v60
    v_exp_f32 v61, v61
    v_exp_f32 v62, v62
    v_exp_f32 v63, v63
    v_mfma_f32_32x32x16_bf16 v[32:47], v[128:131], v[98:101], 0
    ds_read_b128 v[168:171], v3 offset:47104
    v_exp_f32 v64, v64
    v_exp_f32 v65, v65
    v_exp_f32 v66, v66
    v_exp_f32 v67, v67
    v_mfma_f32_32x32x16_bf16 v[32:47], v[132:135], v[102:105], v[32:47]
    ds_read_b128 v[172:175], v3 offset:48128
    v_exp_f32 v68, v68
    v_exp_f32 v69, v69
    v_exp_f32 v70, v70
    v_exp_f32 v71, v71
    v_smfmac_f32_32x32x32_bf16 v[82:97], v[148:151], v[56:63], v5
    s_setprio 1
    v_exp_f32 v72, v72
    v_exp_f32 v73, v73
    v_exp_f32 v74, v74
    v_exp_f32 v75, v75
    v_smfmac_f32_32x32x32_bf16 v[82:97], v[152:155], v[64:71], v5
    s_waitcnt lgkmcnt(0)
    v_exp_f32 v76, v76
    v_exp_f32 v77, v77
    v_exp_f32 v78, v78
    v_exp_f32 v79, v79
    v_mfma_f32_32x32x16_bf16 v[48:63], v[136:139], v[98:101], 0
    v_exp_f32 v32, v32
    v_exp_f32 v33, v33
    v_exp_f32 v34, v34
    v_exp_f32 v35, v35
    v_mfma_f32_32x32x16_bf16 v[48:63], v[140:143], v[102:105], v[48:63]
    v_exp_f32 v36, v36
    v_exp_f32 v37, v37
    v_exp_f32 v38, v38
    v_exp_f32 v39, v39
    v_smfmac_f32_32x32x32_bf16 v[82:97], v[156:159], v[72:79], v5
    s_setprio 1
    v_exp_f32 v40, v40
    v_exp_f32 v41, v41
    v_exp_f32 v42, v42
    v_exp_f32 v43, v43
    v_smfmac_f32_32x32x32_bf16 v[82:97], v[160:163], v[32:39], v5
    s_waitcnt lgkmcnt(0)
    v_exp_f32 v44, v44
    v_exp_f32 v45, v45
    v_exp_f32 v46, v46
    v_exp_f32 v47, v47
    v_exp_f32 v48, v48
    v_exp_f32 v49, v49
    v_exp_f32 v50, v50
    v_exp_f32 v51, v51
    v_exp_f32 v52, v52
    v_exp_f32 v53, v53
    v_exp_f32 v54, v54
    v_exp_f32 v55, v55
    v_smfmac_f32_32x32x32_bf16 v[82:97], v[164:167], v[40:47], v5
    s_setprio 0
    v_exp_f32 v56, v56
    v_exp_f32 v57, v57
    v_exp_f32 v58, v58
    v_exp_f32 v59, v59
    v_smfmac_f32_32x32x32_bf16 v[82:97], v[168:171], v[48:55], v5
    s_waitcnt lgkmcnt(0)
    buffer_load_dwordx2 v[124:125], v178, s[16:19], s41 offen sc1
    v_exp_f32 v60, v60
    v_exp_f32 v61, v61
    v_exp_f32 v62, v62
    v_exp_f32 v63, v63
    s_nop 1
    v_smfmac_f32_32x32x32_bf16 v[82:97], v[172:175], v[56:63], v5
    s_mul_i32 s34, s31, 2304
    s_xor_b32 s35, s31, 4
    s_mul_i32 s35, s35, 2304
    v_add_u32 v16, s34, v123
    v_add_u32 v17, s35, v123
    v_lshl_add_u32 v18, v1, 2, s34
    v_or_b32 v19, 32, v1
    v_lshl_add_u32 v20, v19, 2, s35
    v_lshl_add_u32 v19, v19, 2, s34
    s_nop 0
    s_cmp_lg_u32 s60, 0
    s_cbranch_scc1 L_halfB_14
    ds_write_b128 v16, v[90:93]
    ds_write_b128 v16, v[94:97] offset:1024
    ds_write_b32 v18, v94 offset:2048
    s_branch L_join_15
L_halfB_14:
    ds_write_b128 v16, v[82:85]
    ds_write_b128 v16, v[86:89] offset:1024
    ds_write_b32 v18, v94 offset:2048
    s_nop 1

    v_mov_b32 v82, v90
    v_mov_b32 v83, v91
    v_mov_b32 v84, v92
    v_mov_b32 v85, v93
    v_mov_b32 v86, v94
    v_mov_b32 v87, v95
    v_mov_b32 v88, v96
    v_mov_b32 v89, v97
L_join_15:
    s_waitcnt vmcnt(2) lgkmcnt(0)
    s_barrier

    ds_read_b32 v114, v19 offset:2048
    ds_read_b32 v115, v20 offset:2048
    ds_read_b128 v[106:109], v17
    ds_read_b128 v[110:113], v17 offset:1024
    s_waitcnt lgkmcnt(2)
    v_add_f32 v114, v114, v115
    v_rcp_f32 v115, v114
    s_mov_b32 s34, 0x2b800000
    s_mov_b32 s35, 0x53800000
    s_waitcnt lgkmcnt(0)

    v_pk_add_f32 v[82:83], v[82:83], v[106:107]
    v_pk_add_f32 v[84:85], v[84:85], v[108:109]
    v_pk_add_f32 v[86:87], v[86:87], v[110:111]
    v_pk_add_f32 v[88:89], v[88:89], v[112:113]
    v_pk_mul_f32 v[116:117], v[82:83], 0
    v_pk_fma_f32 v[116:117], v[84:85], 0, v[116:117]
    v_pk_fma_f32 v[116:117], v[86:87], 0, v[116:117]
    v_pk_fma_f32 v[116:117], v[88:89], 0, v[116:117]
    v_add_f32 v116, v116, v117
    v_add_f32 v114, v114, v116
    v_cmp_nle_f32 vcc, s34, v114
    v_cmp_nge_f32 s[58:59], s35, v114
    s_nop 0
    s_or_b64 vcc, vcc, s[58:59]
    s_cbranch_scc1 L_slow_16
L_store_17:
    s_mov_b32 s35, 0xfffffffe

    v_pk_mul_f32 v[82:83], v[82:83], v[114:115] op_sel:[0,1] op_sel_hi:[1,1]
    v_pk_mul_f32 v[84:85], v[84:85], v[114:115] op_sel:[0,1] op_sel_hi:[1,1]
    v_pk_mul_f32 v[86:87], v[86:87], v[114:115] op_sel:[0,1] op_sel_hi:[1,1]
    v_pk_mul_f32 v[88:89], v[88:89], v[114:115] op_sel:[0,1] op_sel_hi:[1,1]
    v_cvt_pk_bf16_f32 v106, v82, v83
    v_cvt_pk_bf16_f32 v107, v84, v85
    v_cvt_pk_bf16_f32 v108, v86, v87
    v_cvt_pk_bf16_f32 v109, v88, v89
    v_min_u32 v106, s35, v106
    v_min_u32 v107, s35, v107
    v_min_u32 v108, s35, v108
    v_min_u32 v109, s35, v109
    s_cmp_eq_u32 s60, 0
    s_cbranch_scc1 L_nz_18
    s_mov_b32 exec_lo, 0
    v_mov_b32 v108, 0
    v_mov_b32 v109, 0
    s_mov_b32 exec_lo, -1
L_nz_18:
    buffer_store_dwordx4 v[106:109], v123, s[16:19], s40 offen sc1
    s_cmp_ge_u32 s2, 224
    s_cbranch_scc1 L_done

    v_mov_b32 v2, v178
    v_lshrrev_b32 v16, 4, v1
    v_and_b32 v17, 15, v1
    v_bfe_u32 v18, v1, 2, 2
    v_bfe_u32 v19, v1, 4, 1
    v_lshrrev_b32 v20, 5, v1
    v_lshl_add_u32 v21, v19, 2, v18
    v_lshl_add_u32 v21, v20, 4, v21
    v_lshrrev_b32 v22, 1, v18
    v_lshl_add_u32 v22, v19, 1, v22
    v_lshlrev_b32 v22, 5, v22
    v_lshl_add_u32 v21, v21, 7, v22
    v_and_b32 v22, 3, v1
    v_lshl_add_u32 v21, v22, 3, v21
    s_mul_i32 s34, s60, 28672
    s_add_u32 s34, s34, 98304
    v_add_u32 v8, s34, v21
    v_xor_b32 v9, 32, v8
    v_xor_b32 v10, 64, v8
    v_xor_b32 v11, 0x60, v8

    ds_read_b64_tr_b16 v[128:129], v8 offset:0
    ds_read_b64_tr_b16 v[130:131], v8 offset:1024
    ds_read_b64_tr_b16 v[132:133], v9 offset:0
    ds_read_b64_tr_b16 v[134:135], v9 offset:1024
    ds_read_b64_tr_b16 v[136:137], v10 offset:0
    ds_read_b64_tr_b16 v[138:139], v10 offset:1024
    ds_read_b64_tr_b16 v[140:141], v11 offset:0
    ds_read_b64_tr_b16 v[142:143], v11 offset:1024
    s_waitcnt lgkmcnt(4)
    ds_read_b64_tr_b16 v[144:145], v10 offset:3584
    ds_read_b64_tr_b16 v[146:147], v10 offset:4608
    ds_read_b64_tr_b16 v[148:149], v11 offset:3584
    ds_read_b64_tr_b16 v[150:151], v11 offset:4608
    ds_read_b64_tr_b16 v[152:153], v8 offset:3584
    ds_read_b64_tr_b16 v[154:155], v8 offset:4608
    ds_read_b64_tr_b16 v[156:157], v9 offset:3584
    ds_read_b64_tr_b16 v[158:159], v9 offset:4608
    s_waitcnt lgkmcnt(4)
    ds_read_b64_tr_b16 v[160:161], v8 offset:7168
    ds_read_b64_tr_b16 v[162:163], v8 offset:8192
    ds_read_b64_tr_b16 v[164:165], v9 offset:7168
    ds_read_b64_tr_b16 v[166:167], v9 offset:8192
    ds_read_b64_tr_b16 v[168:169], v10 offset:7168
    ds_read_b64_tr_b16 v[170:171], v10 offset:8192
    ds_read_b64_tr_b16 v[172:173], v11 offset:7168
    ds_read_b64_tr_b16 v[174:175], v11 offset:8192
    s_waitcnt lgkmcnt(4)
    ds_read_b64_tr_b16 v[176:177], v10 offset:10752
    ds_read_b64_tr_b16 v[178:179], v10 offset:11776
    ds_read_b64_tr_b16 v[180:181], v11 offset:10752
    ds_read_b64_tr_b16 v[182:183], v11 offset:11776
    ds_read_b64_tr_b16 v[184:185], v8 offset:10752
    ds_read_b64_tr_b16 v[186:187], v8 offset:11776
    ds_read_b64_tr_b16 v[188:189], v9 offset:10752
    ds_read_b64_tr_b16 v[190:191], v9 offset:11776
    s_waitcnt lgkmcnt(4)
    v_lshlrev_b32 v3, 9, v16
    v_lshl_add_u32 v3, v17, 4, v3
    s_lshl_b32 s34, s52, 1
    s_lshr_b32 s35, s61, 1
    s_add_u32 s34, s34, s35
    s_lshl_b32 s34, s34, 15
    s_lshl_b32 s35, s60, 14
    s_add_u32 s48, s34, s35
    s_and_b32 s34, s61, 1
    s_lshl_b32 s34, s34, 8
    s_add_u32 s48, s48, s34
    s_add_u32 s48, s48, 8388608
    s_add_u32 s46, s48, 4096
    s_add_u32 s47, s48, 8192
    s_add_u32 s51, s48, 12288
    v_and_b32 v20, 7, v1
    v_lshlrev_b32 v21, 2, v1
    v_and_b32 v21, 8, v21
    v_or_b32 v20, v20, v21
    v_lshrrev_b32 v21, 1, v1
    v_and_b32 v21, 8, v21
    v_lshrrev_b32 v22, 5, v1
    v_or_b32 v21, v21, v22
    v_xor_b32 v20, v20, v21
    v_lshlrev_b32 v20, 4, v20
    v_lshl_add_u32 v20, v17, 8, v20
    s_lshl_b32 s34, s31, 12
    v_add_u32 v24, s34, v20
    v_xor_b32 v25, 32, v24
    v_xor_b32 v26, 64, v24
    v_xor_b32 v27, 0x60, v24
    v_lshrrev_b32 v21, 3, v0
    v_and_b32 v22, 7, v0
    v_and_b32 v18, 7, v21
    v_lshlrev_b32 v19, 2, v21
    v_and_b32 v19, 8, v19
    v_or_b32 v18, v18, v19
    v_xor_b32 v18, v18, v22
    v_lshlrev_b32 v18, 4, v18
    v_lshl_add_u32 v18, v21, 8, v18
    v_xor_b32 v19, 0x80, v18
    v_and_b32 v20, 0x33, v21
    v_lshlrev_b32 v23, 1, v21
    v_and_b32 v23, 8, v23
    v_lshrrev_b32 v21, 1, v21
    v_and_b32 v21, 4, v21
    v_or3_b32 v20, v20, v23, v21
    v_mul_u32_u24 v20, 896, v20
    v_lshl_add_u32 v20, v22, 4, v20
    s_mul_i32 s50, s52, 57344
    s_add_u32 s50, s50, s49
    s_waitcnt vmcnt(1)

    v_cmp_ne_u64 vcc, v[124:125], v[80:81]
    s_nop 0
    s_cmp_lg_u64 vcc, 0
    s_cbranch_scc1 L_f2r_19
L_f2b_20:

    s_mov_b32 s35, 0

    buffer_load_dwordx4 v[48:51], v3, s[16:19], s48 offen offset:0 sc1
    buffer_load_dwordx4 v[52:55], v3, s[16:19], s48 offen offset:2048 sc1
    buffer_load_dwordx4 v[56:59], v3, s[16:19], s46 offen offset:0 sc1
    buffer_load_dwordx4 v[60:63], v3, s[16:19], s46 offen offset:2048 sc1
    buffer_load_dwordx4 v[64:67], v3, s[16:19], s47 offen offset:0 sc1
    buffer_load_dwordx4 v[68:71], v3, s[16:19], s47 offen offset:2048 sc1
    buffer_load_dwordx4 v[72:75], v3, s[16:19], s51 offen offset:0 sc1
    buffer_load_dwordx4 v[76:79], v3, s[16:19], s51 offen offset:2048 sc1
    ds_read_b64_tr_b16 v[192:193], v8 offset:14336
    ds_read_b64_tr_b16 v[194:195], v8 offset:15360
    ds_read_b64_tr_b16 v[196:197], v9 offset:14336
    ds_read_b64_tr_b16 v[198:199], v9 offset:15360
    ds_read_b64_tr_b16 v[200:201], v10 offset:14336
    ds_read_b64_tr_b16 v[202:203], v10 offset:15360
    ds_read_b64_tr_b16 v[204:205], v11 offset:14336
    ds_read_b64_tr_b16 v[206:207], v11 offset:15360
    s_waitcnt lgkmcnt(4)
    ds_read_b64_tr_b16 v[208:209], v10 offset:17920
    ds_read_b64_tr_b16 v[210:211], v10 offset:18944
    ds_read_b64_tr_b16 v[212:213], v11 offset:17920
    ds_read_b64_tr_b16 v[214:215], v11 offset:18944
    ds_read_b64_tr_b16 v[216:217], v8 offset:17920
    ds_read_b64_tr_b16 v[218:219], v8 offset:18944
    ds_read_b64_tr_b16 v[220:221], v9 offset:17920
    ds_read_b64_tr_b16 v[222:223], v9 offset:18944
    s_waitcnt lgkmcnt(4)
    ds_read_b64_tr_b16 v[224:225], v8 offset:21504
    ds_read_b64_tr_b16 v[226:227], v8 offset:22528
    ds_read_b64_tr_b16 v[228:229], v9 offset:21504
    ds_read_b64_tr_b16 v[230:231], v9 offset:22528
    ds_read_b64_tr_b16 v[232:233], v10 offset:21504
    ds_read_b64_tr_b16 v[234:235], v10 offset:22528
    ds_read_b64_tr_b16 v[236:237], v11 offset:21504
    ds_read_b64_tr_b16 v[238:239], v11 offset:22528
    s_waitcnt lgkmcnt(4)
    ds_read_b64_tr_b16 v[240:241], v10 offset:25088
    ds_read_b64_tr_b16 v[242:243], v10 offset:26112
    ds_read_b64_tr_b16 v[244:245], v11 offset:25088
    ds_read_b64_tr_b16 v[246:247], v11 offset:26112
    ds_read_b64_tr_b16 v[248:249], v8 offset:25088
    ds_read_b64_tr_b16 v[250:251], v8 offset:26112
    ds_read_b64_tr_b16 v[252:253], v9 offset:25088
    ds_read_b64_tr_b16 v[254:255], v9 offset:26112
    s_waitcnt lgkmcnt(4)
    s_branch L_o2_22
L_o_21:
    buffer_load_dwordx4 v[48:51], v3, s[16:19], s48 offen offset:0 sc1
    buffer_load_dwordx4 v[52:55], v3, s[16:19], s48 offen offset:2048 sc1
    buffer_load_dwordx4 v[56:59], v3, s[16:19], s46 offen offset:0 sc1
    buffer_load_dwordx4 v[60:63], v3, s[16:19], s46 offen offset:2048 sc1
    buffer_load_dwordx4 v[64:67], v3, s[16:19], s47 offen offset:0 sc1
    buffer_load_dwordx4 v[68:71], v3, s[16:19], s47 offen offset:2048 sc1
    buffer_load_dwordx4 v[72:75], v3, s[16:19], s51 offen offset:0 sc1
    buffer_load_dwordx4 v[76:79], v3, s[16:19], s51 offen offset:2048 sc1
L_o2_22:
    s_waitcnt vmcnt(7) lgkmcnt(0)
    v_mfma_f32_16x16x32_bf16 v[32:35], v[128:131], v[48:51], 0
    v_mfma_f32_16x16x32_bf16 v[36:39], v[132:135], v[48:51], 0
    v_mfma_f32_16x16x32_bf16 v[40:43], v[136:139], v[48:51], 0
    v_mfma_f32_16x16x32_bf16 v[44:47], v[140:143], v[48:51], 0
    v_max3_u32 v21, v48, v49, v50
    v_max_u32 v21, v21, v51
    s_waitcnt vmcnt(6) lgkmcnt(0)
    v_mfma_f32_16x16x32_bf16 v[32:35], v[144:147], v[52:55], v[32:35]
    v_mfma_f32_16x16x32_bf16 v[36:39], v[148:151], v[52:55], v[36:39]
    v_mfma_f32_16x16x32_bf16 v[40:43], v[152:155], v[52:55], v[40:43]
    v_mfma_f32_16x16x32_bf16 v[44:47], v[156:159], v[52:55], v[44:47]
    v_max3_u32 v21, v21, v52, v53
    v_max3_u32 v21, v21, v54, v55
    s_waitcnt vmcnt(5) lgkmcnt(0)
    v_mfma_f32_16x16x32_bf16 v[32:35], v[160:163], v[56:59], v[32:35]
    v_mfma_f32_16x16x32_bf16 v[36:39], v[164:167], v[56:59], v[36:39]
    v_mfma_f32_16x16x32_bf16 v[40:43], v[168:171], v[56:59], v[40:43]
    v_mfma_f32_16x16x32_bf16 v[44:47], v[172:175], v[56:59], v[44:47]
    v_max3_u32 v21, v21, v56, v57
    v_max3_u32 v21, v21, v58, v59
    s_waitcnt vmcnt(4) lgkmcnt(0)
    v_mfma_f32_16x16x32_bf16 v[32:35], v[176:179], v[60:63], v[32:35]
    v_mfma_f32_16x16x32_bf16 v[36:39], v[180:183], v[60:63], v[36:39]
    v_mfma_f32_16x16x32_bf16 v[40:43], v[184:187], v[60:63], v[40:43]
    v_mfma_f32_16x16x32_bf16 v[44:47], v[188:191], v[60:63], v[44:47]
    v_max3_u32 v21, v21, v60, v61
    v_max3_u32 v21, v21, v62, v63
    s_waitcnt vmcnt(3) lgkmcnt(0)
    v_mfma_f32_16x16x32_bf16 v[32:35], v[192:195], v[64:67], v[32:35]
    v_mfma_f32_16x16x32_bf16 v[36:39], v[196:199], v[64:67], v[36:39]
    v_mfma_f32_16x16x32_bf16 v[40:43], v[200:203], v[64:67], v[40:43]
    v_mfma_f32_16x16x32_bf16 v[44:47], v[204:207], v[64:67], v[44:47]
    v_max3_u32 v21, v21, v64, v65
    v_max3_u32 v21, v21, v66, v67
    s_waitcnt vmcnt(2) lgkmcnt(0)
    v_mfma_f32_16x16x32_bf16 v[32:35], v[208:211], v[68:71], v[32:35]
    v_mfma_f32_16x16x32_bf16 v[36:39], v[212:215], v[68:71], v[36:39]
    v_mfma_f32_16x16x32_bf16 v[40:43], v[216:219], v[68:71], v[40:43]
    v_mfma_f32_16x16x32_bf16 v[44:47], v[220:223], v[68:71], v[44:47]
    v_max3_u32 v21, v21, v68, v69
    v_max3_u32 v21, v21, v70, v71
    s_waitcnt vmcnt(1) lgkmcnt(0)
    v_mfma_f32_16x16x32_bf16 v[32:35], v[224:227], v[72:75], v[32:35]
    v_mfma_f32_16x16x32_bf16 v[36:39], v[228:231], v[72:75], v[36:39]
    v_mfma_f32_16x16x32_bf16 v[40:43], v[232:235], v[72:75], v[40:43]
    v_mfma_f32_16x16x32_bf16 v[44:47], v[236:239], v[72:75], v[44:47]
    v_max3_u32 v21, v21, v72, v73
    v_max3_u32 v21, v21, v74, v75
    s_waitcnt vmcnt(0) lgkmcnt(0)
    v_mfma_f32_16x16x32_bf16 v[32:35], v[240:243], v[76:79], v[32:35]
    v_mfma_f32_16x16x32_bf16 v[36:39], v[244:247], v[76:79], v[36:39]
    v_mfma_f32_16x16x32_bf16 v[40:43], v[248:251], v[76:79], v[40:43]
    v_mfma_f32_16x16x32_bf16 v[44:47], v[252:255], v[76:79], v[44:47]
    v_max3_u32 v21, v21, v76, v77
    v_max3_u32 v21, v21, v78, v79
    v_cmp_eq_u32 vcc, -1, v21
    s_add_u32 s35, s35, 1
    s_cmp_ge_u32 s35, 262144
    s_cbranch_scc1 L_od_23
    s_cmp_lg_u64 vcc, 0
    s_cbranch_scc1 L_o_21
L_od_23:

    s_nop 1
    ds_write_b128 v24, v[32:35] offset:20480
    ds_write_b128 v25, v[36:39] offset:20480
    ds_write_b128 v26, v[40:43] offset:20480
    ds_write_b128 v27, v[44:47] offset:20480
    s_waitcnt lgkmcnt(0)
    s_barrier
    ds_read_b128 v[106:109], v18 offset:20480
    ds_read_b128 v[114:117], v18 offset:36864
    ds_read_b128 v[110:113], v19 offset:20480
    ds_read_b128 v[118:121], v19 offset:36864
    s_waitcnt lgkmcnt(2)

    v_pk_add_f32 v[106:107], v[106:107], v[114:115]
    v_pk_add_f32 v[108:109], v[108:109], v[116:117]
    s_waitcnt lgkmcnt(0)
    v_pk_add_f32 v[110:111], v[110:111], v[118:119]
    v_pk_add_f32 v[112:113], v[112:113], v[120:121]
    v_cvt_pk_bf16_f32 v114, v106, v107
    v_cvt_pk_bf16_f32 v115, v108, v109
    v_cvt_pk_bf16_f32 v116, v110, v111
    v_cvt_pk_bf16_f32 v117, v112, v113
    buffer_store_dwordx4 v[114:117], v20, s[24:27], s50 offen sc0 sc1
L_done:
    s_endpgm
L_f2r_19:
    s_mov_b32 s35, 0

L_f2l_24:
    s_sleep 2
    buffer_load_dwordx2 v[124:125], v2, s[16:19], s41 offen sc1
    s_add_u32 s35, s35, 1
    s_waitcnt vmcnt(0)
    v_cmp_ne_u64 vcc, v[124:125], v[80:81]
    s_cmp_ge_u32 s35, 262144
    s_cbranch_scc1 L_f2b_20
    s_cmp_lg_u64 vcc, 0
    s_cbranch_scc1 L_f2l_24
    s_branch L_f2b_20

L_spare_1:
    s_cmp_lg_u32 s2, 196
    s_cbranch_scc1 L_nonon_3
    s_or_b32 s62, s62, 1
    v_mov_b32 v80, s62
    v_mov_b32 v81, s63
    buffer_store_dwordx2 v[80:81], v6, s[4:7], 0 offen sc1
    s_waitcnt vmcnt(0)
    v_lshlrev_b32 v26, 7, v0

L_nonon_3:
    buffer_load_dwordx2 v[80:81], v7, s[4:7], 0 offen sc1
    s_branch L_pub_5

L_slow_16:
    s_mov_b32 exec_lo, 0
    v_mov_b32 v104, 0
    v_mov_b32 v105, 0
    s_mov_b32 exec_lo, -1
    v_mov_b32 v16, 0xff800000
    s_lshl_b32 s46, s32, 18
    s_mov_b32 s48, 0
L_s1_25:
    buffer_load_dwordx4 v[128:131], v123, s[16:19], s46 offen sc1
    buffer_load_dwordx4 v[132:135], v123, s[16:19], s46 offen offset:1024 sc1
    s_waitcnt vmcnt(0)

    v_mfma_f32_32x32x16_bf16 v[32:47], v[128:131], v[98:101], 0
    v_mfma_f32_32x32x16_bf16 v[32:47], v[132:135], v[102:105], v[32:47]
    s_nop 15
    v_max3_f32 v16, v16, v32, v33
    v_max3_f32 v16, v16, v34, v35
    v_max3_f32 v16, v16, v36, v37
    v_max3_f32 v16, v16, v38, v39
    v_max3_f32 v16, v16, v40, v41
    v_max3_f32 v16, v16, v42, v43
    v_max3_f32 v16, v16, v44, v45
    v_max3_f32 v16, v16, v46, v47
    s_add_u32 s46, s46, 4096
    s_add_u32 s48, s48, 1
    s_cmp_lt_u32 s48, 64
    s_cbranch_scc1 L_s1_25
    v_mov_b32 v17, v16
    s_nop 1
    v_permlane32_swap_b32 v16, v17
    s_nop 1
    v_max_f32 v16, v16, v17
    v_and_b32 v17, 0xffff0000, v16
    v_sub_f32 v18, v16, v17
    v_and_b32 v19, 0xffff0000, v18
    v_sub_f32 v18, v18, v19
    s_mov_b32 exec_lo, 0
    v_cvt_pk_bf16_f32 v104, -v17, -v19
    v_cvt_pk_bf16_f32 v105, -v18, 0
    s_mov_b32 exec_lo, -1

    v_mov_b32 v82, 0
    v_mov_b32 v83, 0
    v_mov_b32 v84, 0
    v_mov_b32 v85, 0
    v_mov_b32 v86, 0
    v_mov_b32 v87, 0
    v_mov_b32 v88, 0
    v_mov_b32 v89, 0
    v_mov_b32 v90, 0
    v_mov_b32 v91, 0
    v_mov_b32 v92, 0
    v_mov_b32 v93, 0
    v_mov_b32 v94, 0
    v_mov_b32 v95, 0
    v_mov_b32 v96, 0
    v_mov_b32 v97, 0
    s_lshl_b32 s46, s32, 18
    s_mov_b32 s48, 0
L_s2_26:
    buffer_load_dwordx4 v[128:131], v123, s[16:19], s46 offen sc1
    buffer_load_dwordx4 v[132:135], v123, s[16:19], s46 offen offset:1024 sc1
    buffer_load_dwordx4 v[144:147], v123, s[16:19], s46 offen offset:2048 sc1
    buffer_load_dwordx4 v[148:151], v123, s[16:19], s46 offen offset:3072 sc1
    s_waitcnt vmcnt(0)

    v_mfma_f32_32x32x16_bf16 v[32:47], v[128:131], v[98:101], 0
    v_mfma_f32_32x32x16_bf16 v[32:47], v[132:135], v[102:105], v[32:47]
    s_nop 15
    v_exp_f32 v32, v32
    v_exp_f32 v33, v33
    v_exp_f32 v34, v34
    v_exp_f32 v35, v35
    v_exp_f32 v36, v36
    v_exp_f32 v37, v37
    v_exp_f32 v38, v38
    v_exp_f32 v39, v39
    v_exp_f32 v40, v40
    v_exp_f32 v41, v41
    v_exp_f32 v42, v42
    v_exp_f32 v43, v43
    v_exp_f32 v44, v44
    v_exp_f32 v45, v45
    v_exp_f32 v46, v46
    v_exp_f32 v47, v47
    s_nop 1
    v_smfmac_f32_32x32x32_bf16 v[82:97], v[144:147], v[32:39], v5
    v_smfmac_f32_32x32x32_bf16 v[82:97], v[148:151], v[40:47], v5
    s_nop 7
    s_add_u32 s46, s46, 4096
    s_add_u32 s48, s48, 1
    s_cmp_lt_u32 s48, 64
    s_cbranch_scc1 L_s2_26
    s_nop 15
    v_mov_b32 v114, v94
    v_mov_b32 v115, v94
    s_nop 1
    v_permlane32_swap_b32 v114, v115
    s_nop 1
    v_rcp_f32 v115, v115
    s_cmp_eq_u32 s60, 0
    s_cbranch_scc1 L_sh_27

    v_mov_b32 v82, v90
    v_mov_b32 v83, v91
    v_mov_b32 v84, v92
    v_mov_b32 v85, v93
    v_mov_b32 v86, v94
    v_mov_b32 v87, v95
    v_mov_b32 v88, v96
    v_mov_b32 v89, v97
L_sh_27:
    s_nop 1
    s_branch L_store_17

L_end:
.section .rodata,"a"
.p2align 6
.amdhsa_kernel standalone__softmax_full_mha__prompt_kernel
  .amdhsa_next_free_vgpr 256
  .amdhsa_next_free_sgpr 102
  .amdhsa_accum_offset 256
  .amdhsa_group_segment_fixed_size 0
  .amdhsa_kernarg_size 48
  .amdhsa_user_sgpr_count 2
  .amdhsa_user_sgpr_kernarg_segment_ptr 1
  .amdhsa_system_sgpr_workgroup_id_x 1
.end_amdhsa_kernel
```
